```python
import torch

def _softmax(x, axis=-1):
    return torch.softmax(x, dim=axis)
def _gelu(x):
    return torch.nn.functional.gelu(x, approximate="tanh")
def _silu(x):
    return torch.nn.functional.silu(x)
def _sigmoid(x):
    return torch.sigmoid(x)
def _layernorm(x, axis=-1, eps=1e-5):
    m = x.mean(dim=axis, keepdim=True)
    v = x.var(dim=axis, keepdim=True, unbiased=False)
    return (x - m) / torch.sqrt(v + eps)
def _scatter_add(tgt, idx, src, axis=0):
    return tgt.clone().index_add_(axis, idx, src)
def _segment_sum(src, seg, n):
    out = torch.zeros((n,) + src.shape[1:], dtype=src.dtype)
    return out.index_add_(0, seg, src)
def _pad(x, pw):
    flat = tuple(v for pair in reversed(pw) for v in pair)
    return torch.nn.functional.pad(x, flat)

kernel_name = 'sequential_preLN__softmax_full_mha__geglu_ffn__prompt'

def setup_inputs():

    _w = (lambda a: (lambda t: t.to(torch.bfloat16) if t.is_floating_point() else t)(torch.as_tensor(a)))
    def _A_setup():
        B, S, D = 1, 2048, 512
        return {
            "x": _w((lambda *s: torch.randn(*s, dtype=torch.bfloat16) * 0.05)(B, S, D)),
            "wqkv": _w((lambda *s: torch.randn(*s, dtype=torch.bfloat16) * 0.05)(D, 3 * D)),
            "wo": _w((lambda *s: torch.randn(*s, dtype=torch.bfloat16) * 0.05)(D, D)),
        }
    _A_in = _A_setup()

    def _B_setup():
        B, S, D, F = 1, 2048, 512, 1376
        return {
            "x": _w((lambda *s: torch.randn(*s, dtype=torch.bfloat16) * 0.05)(B, S, D)),
            "w_gate": _w((lambda *s: torch.randn(*s, dtype=torch.bfloat16) * 0.05)(D, F)),
            "w_up": _w((lambda *s: torch.randn(*s, dtype=torch.bfloat16) * 0.05)(D, F)),
            "w_down": _w((lambda *s: torch.randn(*s, dtype=torch.bfloat16) * 0.05)(F, D)),
        }
    _B_in = _B_setup()

    return {
        "A_x": _A_in["x"],
        "A_wqkv": _A_in["wqkv"],
        "A_wo": _A_in["wo"],
        "B_x": _B_in["x"],
        "B_w_gate": _B_in["w_gate"],
        "B_w_up": _B_in["w_up"],
        "B_w_down": _B_in["w_down"],
    }

def reference(A_x, A_wqkv, A_wo, B_x, B_w_gate, B_w_up, B_w_down):
    def _A_ref(x, wqkv, wo):
        B, S, D = x.shape
        H = 32; Dh = D // H
        qkv = (lambda x, *d: x.permute(*d))((x @ wqkv).reshape(B, S, 3, H, Dh), 2, 0, 3, 1, 4)
        q, k, v = qkv[0], qkv[1], qkv[2]
        scale = Dh ** -0.5
        scores = torch.einsum("bhqd,bhkd->bhqk", q, k) * scale
        p = _softmax(scores, axis=-1)
        o = torch.einsum("bhqk,bhkd->bhqd", p, v)
        return (lambda x, *d: x.permute(*d))(o, 0, 2, 1, 3).reshape(B, S, D) @ wo

    def _B_ref(x, w_gate, w_up, w_down):
        return (_gelu(x @ w_gate) * (x @ w_up)) @ w_down

    x = A_x
    h = x + _A_ref(_layernorm(x, axis=-1), A_wqkv, A_wo)
    h2 = h + _B_ref(_layernorm(h, axis=-1), B_w_gate, B_w_up, B_w_down)
    return h2
```

```asm
; @launch kernel=qkv_kernel grid=(256,1,1) block=(768,1,1) lds=163840
; @launch kernel=main_kernel grid=(256,1,1) block=(704,1,1) lds=163840
.amdgcn_target "amdgcn-amd-amdhsa--gfx950"
.text
.globl qkv_kernel
.p2align 12
.type qkv_kernel,@function
qkv_kernel:
    s_cmp_ge_u32 s2, 256
    s_cbranch_scc1 L_k1_end
    s_load_dwordx4 s[4:7], s[0:1], 0
    s_load_dwordx2 s[8:9], s[0:1], 72
    v_lshrrev_b32 v2, 6, v0
    v_and_b32 v1, 63, v0
    s_and_b32 s37, s2, 7
    v_readfirstlane_b32 s24, v2
    s_lshr_b32 s38, s2, 3
    s_and_b32 s25, s37, 3
    s_lshl_b32 s25, s25, 3
    s_and_b32 s33, s38, 7
    s_add_u32 s25, s25, s33
    s_lshr_b32 s26, s37, 2
    s_lshl_b32 s26, s26, 2
    s_lshr_b32 s38, s38, 3
    s_add_u32 s26, s26, s38
    s_lshl_b32 s38, s38, 1
    s_xor_b32 s33, s33, s38
    v_lshrrev_b32 v2, 3, v1
    v_and_b32 v3, 7, v1
    v_lshlrev_b32 v5, 10, v2
    v_lshl_add_u32 v5, v3, 4, v5
    s_lshl_b32 s29, s25, 16
    s_lshl_b32 s37, s24, 13
    s_add_u32 s29, s29, s37
    s_lshl_b32 s37, s33, 7
    s_add_u32 s29, s29, s37
    s_and_b32 s44, s24, 3
    s_and_b32 s27, s24, 1
    s_bfe_u32 s28, s24, 0x10001
    s_lshl_b32 s40, s26, 7
    s_lshl_b32 s37, s27, 6
    s_add_u32 s40, s40, s37
    s_mul_i32 s37, s28, 49152
    s_add_u32 s40, s40, s37
    s_lshl_b32 s33, s33, 1
    s_mul_i32 s31, s44, 3072
    s_add_u32 s31, s31, 65536
    v_lshrrev_b32 v4, 2, v1
    v_mul_u32_u24 v4, 3072, v4
    v_and_b32 v6, 3, v1
    v_lshl_add_u32 v6, v6, 4, v4
    s_mov_b32 s42, 0
    s_mov_b32 s14, 0x200000
    s_mov_b32 s15, 0x00020000
    s_mov_b32 s18, 0x180000
    s_mov_b32 s19, 0x00020000
    s_waitcnt lgkmcnt(0)
    s_mov_b32 s12, s4
    s_mov_b32 s13, s5
    s_mov_b32 s16, s6
    s_mov_b32 s17, s7
    s_cmp_ge_u32 s24, 8
    s_cbranch_scc1 L_k1_loader
    buffer_load_dwordx4 v[16:19], v5, s[12:15], s29 offen
    s_xor_b32 s38, s29, 128
    buffer_load_dwordx4 v[20:23], v5, s[12:15], s38 offen
    s_xor_b32 s38, s29, 256
    buffer_load_dwordx4 v[24:27], v5, s[12:15], s38 offen
    s_xor_b32 s38, s29, 384
    buffer_load_dwordx4 v[28:31], v5, s[12:15], s38 offen
    s_xor_b32 s38, s29, 512
    buffer_load_dwordx4 v[32:35], v5, s[12:15], s38 offen
    s_xor_b32 s38, s29, 640
    buffer_load_dwordx4 v[36:39], v5, s[12:15], s38 offen
    s_xor_b32 s38, s29, 768
    buffer_load_dwordx4 v[40:43], v5, s[12:15], s38 offen
    s_xor_b32 s38, s29, 896
    buffer_load_dwordx4 v[44:47], v5, s[12:15], s38 offen
    s_mov_b32 s20, s8
    s_mov_b32 s21, s9
    s_mov_b32 s22, 0x1600000
    s_mov_b32 s23, 0x00020000
    v_xor_b32 v4, v2, v3
    v_lshlrev_b32 v4, 4, v4
    v_lshl_add_u32 v4, v3, 9, v4
    s_lshr_b32 s37, s24, 2
    s_lshl_b32 s37, s37, 15
    s_lshl_b32 s38, s44, 7
    s_add_u32 s37, s37, s38
    v_add_u32 v7, s37, v4
    s_mov_b32 s34, 0x3f803f80
    v_and_b32 v2, 31, v1
    v_lshrrev_b32 v4, 5, v1
    v_xor_b32 v3, v2, v4
    v_lshlrev_b32 v3, 4, v3
    v_lshl_add_u32 v3, v4, 9, v3
    s_lshl_b32 s37, s27, 15
    v_add_u32 v9, s37, v3
    v_xor_b32 v10, 32, v9
    v_xor_b32 v11, 64, v9
    v_xor_b32 v12, 96, v9
    s_mul_i32 s37, s28, 3072
    s_add_u32 s37, s37, 65536
    v_lshlrev_b32 v2, 9, v4
    v_bfe_u32 v3, v1, 2, 2
    v_lshl_add_u32 v2, v3, 6, v2
    v_bfe_u32 v3, v1, 4, 1
    v_lshl_add_u32 v2, v3, 5, v2
    v_and_b32 v3, 3, v1
    v_lshl_add_u32 v2, v3, 3, v2
    v_add_u32 v13, s37, v2
    v_add_u32 v14, 49152, v13
    v_lshlrev_b32 v144, 4, v1
    v_bfe_u32 v2, v1, 4, 1
    v_lshlrev_b32 v145, 16, v2
    v_lshl_add_u32 v145, v4, 8, v145
    v_and_b32 v2, 3, v1
    v_lshl_add_u32 v145, v2, 4, v145
    v_bfe_u32 v2, v1, 2, 1
    v_lshl_add_u32 v145, v2, 7, v145
    v_bfe_u32 v2, v1, 3, 1
    v_lshl_add_u32 v145, v2, 6, v145
    v_mov_b32 v48, 0
    v_mov_b32 v49, 0
    v_mov_b32 v50, 0
    v_mov_b32 v51, 0
    v_mov_b32 v52, 0
    v_mov_b32 v53, 0
    v_mov_b32 v54, 0
    v_mov_b32 v55, 0
    v_mov_b32 v56, 0
    v_mov_b32 v57, 0
    v_mov_b32 v58, 0
    v_mov_b32 v59, 0
    v_mov_b32 v60, 0
    v_mov_b32 v61, 0
    v_mov_b32 v62, 0
    v_mov_b32 v63, 0
    v_mov_b32 v64, 0
    v_mov_b32 v65, 0
    v_mov_b32 v66, 0
    v_mov_b32 v67, 0
    v_mov_b32 v68, 0
    v_mov_b32 v69, 0
    v_mov_b32 v70, 0
    v_mov_b32 v71, 0
    v_mov_b32 v72, 0
    v_mov_b32 v73, 0
    v_mov_b32 v74, 0
    v_mov_b32 v75, 0
    v_mov_b32 v76, 0
    v_mov_b32 v77, 0
    v_mov_b32 v78, 0
    v_mov_b32 v79, 0
    v_mov_b32 v80, 0
    v_mov_b32 v81, 0
    v_mov_b32 v82, 0
    v_mov_b32 v83, 0
    v_mov_b32 v84, 0
    v_mov_b32 v85, 0
    v_mov_b32 v86, 0
    v_mov_b32 v87, 0
    v_mov_b32 v88, 0
    v_mov_b32 v89, 0
    v_mov_b32 v90, 0
    v_mov_b32 v91, 0
    v_mov_b32 v92, 0
    v_mov_b32 v93, 0
    v_mov_b32 v94, 0
    v_mov_b32 v95, 0
    v_mov_b32 v128, 0
    v_mov_b32 v129, 0
    v_mov_b32 v130, 0
    v_mov_b32 v131, 0
    s_mov_b64 exec, 0
    s_cmp_eq_u32 s24, 0
    s_cbranch_scc1 L_k1_pad0
    s_cmp_eq_u32 s24, 1
    s_cbranch_scc1 L_k1_pad1
    s_cmp_eq_u32 s24, 2
    s_cbranch_scc1 L_k1_pad2
    s_cmp_eq_u32 s24, 3
    s_cbranch_scc1 L_k1_pad3
    s_cmp_eq_u32 s24, 4
    s_cbranch_scc1 L_k1_pad4
    s_cmp_eq_u32 s24, 5
    s_cbranch_scc1 L_k1_pad5
    s_cmp_eq_u32 s24, 6
    s_cbranch_scc1 L_k1_pad6
    s_cmp_eq_u32 s24, 7
    s_cbranch_scc1 L_k1_pad7
L_k1_wret:
    s_mov_b64 exec, -1
L_k1_pad0:
    s_cbranch_execz L_k1_pad8
    s_waitcnt vmcnt(7)
    v_dot2_f32_bf16 v128, v16, s34, v128
    v_dot2_f32_bf16 v129, v16, v16, v129
    v_dot2_f32_bf16 v130, v17, s34, v130
    v_dot2_f32_bf16 v131, v17, v17, v131
    v_dot2_f32_bf16 v128, v18, s34, v128
    v_dot2_f32_bf16 v129, v18, v18, v129
    v_dot2_f32_bf16 v130, v19, s34, v130
    v_dot2_f32_bf16 v131, v19, v19, v131
    s_waitcnt vmcnt(6)
    v_dot2_f32_bf16 v128, v20, s34, v128
    v_dot2_f32_bf16 v129, v20, v20, v129
L_k1_pad1:
    s_cbranch_execz L_k1_pad9
    v_dot2_f32_bf16 v130, v21, s34, v130
    v_dot2_f32_bf16 v131, v21, v21, v131
    v_dot2_f32_bf16 v128, v22, s34, v128
    v_dot2_f32_bf16 v129, v22, v22, v129
    v_dot2_f32_bf16 v130, v23, s34, v130
    v_dot2_f32_bf16 v131, v23, v23, v131
    s_waitcnt vmcnt(5)
    v_dot2_f32_bf16 v128, v24, s34, v128
    v_dot2_f32_bf16 v129, v24, v24, v129
    v_dot2_f32_bf16 v130, v25, s34, v130
    v_dot2_f32_bf16 v131, v25, v25, v131
    v_dot2_f32_bf16 v128, v26, s34, v128
    v_dot2_f32_bf16 v129, v26, v26, v129
    v_dot2_f32_bf16 v130, v27, s34, v130
    v_dot2_f32_bf16 v131, v27, v27, v131
    s_waitcnt vmcnt(4)
    v_dot2_f32_bf16 v128, v28, s34, v128
    v_dot2_f32_bf16 v129, v28, v28, v129
    v_dot2_f32_bf16 v130, v29, s34, v130
    v_dot2_f32_bf16 v131, v29, v29, v131
    v_dot2_f32_bf16 v128, v30, s34, v128
    v_dot2_f32_bf16 v129, v30, v30, v129
    v_dot2_f32_bf16 v130, v31, s34, v130
    v_dot2_f32_bf16 v131, v31, v31, v131
    s_waitcnt vmcnt(3)
    v_dot2_f32_bf16 v128, v32, s34, v128
    v_dot2_f32_bf16 v129, v32, v32, v129
    v_dot2_f32_bf16 v130, v33, s34, v130
    v_dot2_f32_bf16 v131, v33, v33, v131
    v_dot2_f32_bf16 v128, v34, s34, v128
    v_dot2_f32_bf16 v129, v34, v34, v129
    v_dot2_f32_bf16 v130, v35, s34, v130
    v_dot2_f32_bf16 v131, v35, v35, v131
    s_waitcnt vmcnt(2)
    v_dot2_f32_bf16 v128, v36, s34, v128
    v_dot2_f32_bf16 v129, v36, v36, v129
    v_dot2_f32_bf16 v130, v37, s34, v130
    v_dot2_f32_bf16 v131, v37, v37, v131
    v_dot2_f32_bf16 v128, v38, s34, v128
    v_dot2_f32_bf16 v129, v38, v38, v129
    v_dot2_f32_bf16 v130, v39, s34, v130
    v_dot2_f32_bf16 v131, v39, v39, v131
    s_waitcnt vmcnt(1)
    v_dot2_f32_bf16 v128, v40, s34, v128
    v_dot2_f32_bf16 v129, v40, v40, v129
    v_dot2_f32_bf16 v130, v41, s34, v130
    v_dot2_f32_bf16 v131, v41, v41, v131
    v_dot2_f32_bf16 v128, v42, s34, v128
    v_dot2_f32_bf16 v129, v42, v42, v129
    v_dot2_f32_bf16 v130, v43, s34, v130
    v_dot2_f32_bf16 v131, v43, v43, v131
    s_waitcnt vmcnt(0)
    v_dot2_f32_bf16 v128, v44, s34, v128
    v_dot2_f32_bf16 v129, v44, v44, v129
    v_dot2_f32_bf16 v130, v45, s34, v130
    v_dot2_f32_bf16 v131, v45, v45, v131
    v_dot2_f32_bf16 v128, v46, s34, v128
    v_dot2_f32_bf16 v129, v46, v46, v129
    v_dot2_f32_bf16 v130, v47, s34, v130
    v_dot2_f32_bf16 v131, v47, v47, v131
    s_nop 1
    s_nop 0
    v_add_f32 v128, v128, v130
    v_add_f32 v129, v129, v131
    s_nop 0
    v_add_f32_dpp v128, v128, v128 quad_perm:[1,0,3,2] row_mask:0xf bank_mask:0xf
    v_add_f32_dpp v129, v129, v129 quad_perm:[1,0,3,2] row_mask:0xf bank_mask:0xf
    s_nop 0
    v_add_f32_dpp v128, v128, v128 quad_perm:[2,3,0,1] row_mask:0xf bank_mask:0xf
L_k1_pad2:
    s_cbranch_execz L_k1_pad10
    v_add_f32_dpp v129, v129, v129 quad_perm:[2,3,0,1] row_mask:0xf bank_mask:0xf
    s_nop 0
    v_add_f32_dpp v128, v128, v128 row_half_mirror row_mask:0xf bank_mask:0xf
    v_add_f32_dpp v129, v129, v129 row_half_mirror row_mask:0xf bank_mask:0xf
    v_mul_f32 v128, 0x3b000000, v128
    v_mul_f32 v129, 0x3b000000, v129
    v_fma_f32 v129, -v128, v128, v129
    v_max_f32 v129, 0, v129
    v_add_f32 v129, 0x3727c5ac, v129
    v_rsq_f32 v132, v129
    s_nop 0
    v_mul_f32 v134, v128, v132
    v_sub_f32 v134, 0, v134
    v_lshlrev_b32 v136, 16, v16
    v_and_b32 v137, 0xffff0000, v16
    v_lshlrev_b32 v138, 16, v17
    v_and_b32 v139, 0xffff0000, v17
    v_lshlrev_b32 v140, 16, v18
    v_and_b32 v141, 0xffff0000, v18
    v_lshlrev_b32 v142, 16, v19
    v_and_b32 v143, 0xffff0000, v19
    v_pk_fma_f32 v[136:137], v[136:137], v[132:133], v[134:135] op_sel_hi:[1,0,0]
    v_pk_fma_f32 v[138:139], v[138:139], v[132:133], v[134:135] op_sel_hi:[1,0,0]
    v_pk_fma_f32 v[140:141], v[140:141], v[132:133], v[134:135] op_sel_hi:[1,0,0]
    v_pk_fma_f32 v[142:143], v[142:143], v[132:133], v[134:135] op_sel_hi:[1,0,0]
    v_cvt_pk_bf16_f32 v16, v136, v137
    v_cvt_pk_bf16_f32 v17, v138, v139
    v_cvt_pk_bf16_f32 v18, v140, v141
    v_cvt_pk_bf16_f32 v19, v142, v143
    ds_write_b128 v7, v[16:19] offset:0
    v_lshlrev_b32 v136, 16, v20
    v_and_b32 v137, 0xffff0000, v20
    v_lshlrev_b32 v138, 16, v21
    v_and_b32 v139, 0xffff0000, v21
    v_lshlrev_b32 v140, 16, v22
    v_and_b32 v141, 0xffff0000, v22
    v_lshlrev_b32 v142, 16, v23
    v_and_b32 v143, 0xffff0000, v23
    v_pk_fma_f32 v[136:137], v[136:137], v[132:133], v[134:135] op_sel_hi:[1,0,0]
    v_pk_fma_f32 v[138:139], v[138:139], v[132:133], v[134:135] op_sel_hi:[1,0,0]
    v_pk_fma_f32 v[140:141], v[140:141], v[132:133], v[134:135] op_sel_hi:[1,0,0]
    v_pk_fma_f32 v[142:143], v[142:143], v[132:133], v[134:135] op_sel_hi:[1,0,0]
    v_cvt_pk_bf16_f32 v20, v136, v137
    v_cvt_pk_bf16_f32 v21, v138, v139
    v_cvt_pk_bf16_f32 v22, v140, v141
    v_cvt_pk_bf16_f32 v23, v142, v143
    ds_write_b128 v7, v[20:23] offset:4096
    v_lshlrev_b32 v136, 16, v24
    v_and_b32 v137, 0xffff0000, v24
    v_lshlrev_b32 v138, 16, v25
    v_and_b32 v139, 0xffff0000, v25
    v_lshlrev_b32 v140, 16, v26
    v_and_b32 v141, 0xffff0000, v26
    v_lshlrev_b32 v142, 16, v27
    v_and_b32 v143, 0xffff0000, v27
    v_pk_fma_f32 v[136:137], v[136:137], v[132:133], v[134:135] op_sel_hi:[1,0,0]
    v_pk_fma_f32 v[138:139], v[138:139], v[132:133], v[134:135] op_sel_hi:[1,0,0]
    v_pk_fma_f32 v[140:141], v[140:141], v[132:133], v[134:135] op_sel_hi:[1,0,0]
    v_pk_fma_f32 v[142:143], v[142:143], v[132:133], v[134:135] op_sel_hi:[1,0,0]
    v_cvt_pk_bf16_f32 v24, v136, v137
    v_cvt_pk_bf16_f32 v25, v138, v139
    v_cvt_pk_bf16_f32 v26, v140, v141
    v_cvt_pk_bf16_f32 v27, v142, v143
    ds_write_b128 v7, v[24:27] offset:8192
    v_lshlrev_b32 v136, 16, v28
    v_and_b32 v137, 0xffff0000, v28
    v_lshlrev_b32 v138, 16, v29
    v_and_b32 v139, 0xffff0000, v29
    v_lshlrev_b32 v140, 16, v30
    v_and_b32 v141, 0xffff0000, v30
    v_lshlrev_b32 v142, 16, v31
    v_and_b32 v143, 0xffff0000, v31
    v_pk_fma_f32 v[136:137], v[136:137], v[132:133], v[134:135] op_sel_hi:[1,0,0]
    v_pk_fma_f32 v[138:139], v[138:139], v[132:133], v[134:135] op_sel_hi:[1,0,0]
    v_pk_fma_f32 v[140:141], v[140:141], v[132:133], v[134:135] op_sel_hi:[1,0,0]
L_k1_pad3:
    s_cbranch_execz L_k1_pad11
    v_pk_fma_f32 v[142:143], v[142:143], v[132:133], v[134:135] op_sel_hi:[1,0,0]
    v_cvt_pk_bf16_f32 v28, v136, v137
    v_cvt_pk_bf16_f32 v29, v138, v139
    v_cvt_pk_bf16_f32 v30, v140, v141
    v_cvt_pk_bf16_f32 v31, v142, v143
    ds_write_b128 v7, v[28:31] offset:12288
    v_lshlrev_b32 v136, 16, v32
    v_and_b32 v137, 0xffff0000, v32
    v_lshlrev_b32 v138, 16, v33
    v_and_b32 v139, 0xffff0000, v33
    v_lshlrev_b32 v140, 16, v34
    v_and_b32 v141, 0xffff0000, v34
    v_lshlrev_b32 v142, 16, v35
    v_and_b32 v143, 0xffff0000, v35
    v_pk_fma_f32 v[136:137], v[136:137], v[132:133], v[134:135] op_sel_hi:[1,0,0]
    v_pk_fma_f32 v[138:139], v[138:139], v[132:133], v[134:135] op_sel_hi:[1,0,0]
    v_pk_fma_f32 v[140:141], v[140:141], v[132:133], v[134:135] op_sel_hi:[1,0,0]
    v_pk_fma_f32 v[142:143], v[142:143], v[132:133], v[134:135] op_sel_hi:[1,0,0]
    v_cvt_pk_bf16_f32 v32, v136, v137
    v_cvt_pk_bf16_f32 v33, v138, v139
    v_cvt_pk_bf16_f32 v34, v140, v141
    v_cvt_pk_bf16_f32 v35, v142, v143
    ds_write_b128 v7, v[32:35] offset:16384
    v_lshlrev_b32 v136, 16, v36
    v_and_b32 v137, 0xffff0000, v36
    v_lshlrev_b32 v138, 16, v37
    v_and_b32 v139, 0xffff0000, v37
    v_lshlrev_b32 v140, 16, v38
    v_and_b32 v141, 0xffff0000, v38
    v_lshlrev_b32 v142, 16, v39
    v_and_b32 v143, 0xffff0000, v39
    v_pk_fma_f32 v[136:137], v[136:137], v[132:133], v[134:135] op_sel_hi:[1,0,0]
    v_pk_fma_f32 v[138:139], v[138:139], v[132:133], v[134:135] op_sel_hi:[1,0,0]
    v_pk_fma_f32 v[140:141], v[140:141], v[132:133], v[134:135] op_sel_hi:[1,0,0]
    v_pk_fma_f32 v[142:143], v[142:143], v[132:133], v[134:135] op_sel_hi:[1,0,0]
    v_cvt_pk_bf16_f32 v36, v136, v137
    v_cvt_pk_bf16_f32 v37, v138, v139
    v_cvt_pk_bf16_f32 v38, v140, v141
    v_cvt_pk_bf16_f32 v39, v142, v143
    ds_write_b128 v7, v[36:39] offset:20480
    v_lshlrev_b32 v136, 16, v40
    v_and_b32 v137, 0xffff0000, v40
    v_lshlrev_b32 v138, 16, v41
    v_and_b32 v139, 0xffff0000, v41
    v_lshlrev_b32 v140, 16, v42
    v_and_b32 v141, 0xffff0000, v42
    v_lshlrev_b32 v142, 16, v43
    v_and_b32 v143, 0xffff0000, v43
    v_pk_fma_f32 v[136:137], v[136:137], v[132:133], v[134:135] op_sel_hi:[1,0,0]
    v_pk_fma_f32 v[138:139], v[138:139], v[132:133], v[134:135] op_sel_hi:[1,0,0]
    v_pk_fma_f32 v[140:141], v[140:141], v[132:133], v[134:135] op_sel_hi:[1,0,0]
    v_pk_fma_f32 v[142:143], v[142:143], v[132:133], v[134:135] op_sel_hi:[1,0,0]
    v_cvt_pk_bf16_f32 v40, v136, v137
    v_cvt_pk_bf16_f32 v41, v138, v139
    v_cvt_pk_bf16_f32 v42, v140, v141
    v_cvt_pk_bf16_f32 v43, v142, v143
    ds_write_b128 v7, v[40:43] offset:24576
    v_lshlrev_b32 v136, 16, v44
    v_and_b32 v137, 0xffff0000, v44
    v_lshlrev_b32 v138, 16, v45
    v_and_b32 v139, 0xffff0000, v45
    v_lshlrev_b32 v140, 16, v46
    v_and_b32 v141, 0xffff0000, v46
    v_lshlrev_b32 v142, 16, v47
    v_and_b32 v143, 0xffff0000, v47
    v_pk_fma_f32 v[136:137], v[136:137], v[132:133], v[134:135] op_sel_hi:[1,0,0]
    v_pk_fma_f32 v[138:139], v[138:139], v[132:133], v[134:135] op_sel_hi:[1,0,0]
    v_pk_fma_f32 v[140:141], v[140:141], v[132:133], v[134:135] op_sel_hi:[1,0,0]
    v_pk_fma_f32 v[142:143], v[142:143], v[132:133], v[134:135] op_sel_hi:[1,0,0]
    v_cvt_pk_bf16_f32 v44, v136, v137
    v_cvt_pk_bf16_f32 v45, v138, v139
L_k1_pad4:
    s_cbranch_execz L_k1_pad12
    v_cvt_pk_bf16_f32 v46, v140, v141
    v_cvt_pk_bf16_f32 v47, v142, v143
    ds_write_b128 v7, v[44:47] offset:28672
    s_mov_b32 s32, 0
    s_cmp_lt_u32 s24, 4
    s_cbranch_scc1 L_k1_compute
    s_waitcnt lgkmcnt(0)
    s_endpgm
L_k1_loader:
    s_mov_b32 s32, 0
L_k1_pre0:
    s_xor_b32 s30, s42, s33
    s_mov_b32 m0, s31
    s_mul_i32 s30, s30, 98304
    s_add_u32 s31, s31, 12288
    s_add_u32 s30, s30, s40
    s_add_u32 s42, s42, 1
    buffer_load_dwordx4 v6, s[16:19], s30 offen  lds
    buffer_load_dwordx4 v6, s[16:19], s30 offen offset:1024  lds
    buffer_load_dwordx4 v6, s[16:19], s30 offen offset:2048  lds
    s_cmp_eq_u32 s42, 8
    s_cselect_b32 s37, 98304, 0
    s_sub_u32 s31, s31, s37
    s_cmp_lt_u32 s42, 2
    s_cbranch_scc1 L_k1_pre0
    s_waitcnt vmcnt(0)
L_k1_pre:
    s_xor_b32 s30, s42, s33
    s_mov_b32 m0, s31
    s_mul_i32 s30, s30, 98304
    s_add_u32 s31, s31, 12288
    s_add_u32 s30, s30, s40
    s_add_u32 s42, s42, 1
    buffer_load_dwordx4 v6, s[16:19], s30 offen  lds
    buffer_load_dwordx4 v6, s[16:19], s30 offen offset:1024  lds
    buffer_load_dwordx4 v6, s[16:19], s30 offen offset:2048  lds
    s_cmp_eq_u32 s42, 8
    s_cselect_b32 s37, 98304, 0
    s_sub_u32 s31, s31, s37
    s_cmp_lt_u32 s42, 3
    s_cbranch_scc1 L_k1_pre
    s_waitcnt vmcnt(6)
    s_barrier
    s_xor_b32 s30, s42, s33
    s_mov_b32 m0, s31
    s_mul_i32 s30, s30, 98304
    s_add_u32 s31, s31, 12288
    s_add_u32 s30, s30, s40
    s_add_u32 s42, s42, 1
    buffer_load_dwordx4 v6, s[16:19], s30 offen  lds
    buffer_load_dwordx4 v6, s[16:19], s30 offen offset:1024  lds
    buffer_load_dwordx4 v6, s[16:19], s30 offen offset:2048  lds
    s_cmp_eq_u32 s42, 8
    s_cselect_b32 s37, 98304, 0
    s_sub_u32 s31, s31, s37
    s_xor_b32 s30, s42, s33
    s_mov_b32 m0, s31
    s_mul_i32 s30, s30, 98304
    s_add_u32 s31, s31, 12288
    s_add_u32 s30, s30, s40
    s_add_u32 s42, s42, 1
    buffer_load_dwordx4 v6, s[16:19], s30 offen  lds
    buffer_load_dwordx4 v6, s[16:19], s30 offen offset:1024  lds
    buffer_load_dwordx4 v6, s[16:19], s30 offen offset:2048  lds
    s_cmp_eq_u32 s42, 8
    s_cselect_b32 s37, 98304, 0
    s_sub_u32 s31, s31, s37
    s_waitcnt vmcnt(9)
    s_barrier
    s_xor_b32 s30, s42, s33
    s_mov_b32 m0, s31
    s_mul_i32 s30, s30, 98304
    s_add_u32 s31, s31, 12288
    s_add_u32 s30, s30, s40
    s_add_u32 s42, s42, 1
    buffer_load_dwordx4 v6, s[16:19], s30 offen  lds
    buffer_load_dwordx4 v6, s[16:19], s30 offen offset:1024  lds
    buffer_load_dwordx4 v6, s[16:19], s30 offen offset:2048  lds
    s_cmp_eq_u32 s42, 8
    s_cselect_b32 s37, 98304, 0
    s_sub_u32 s31, s31, s37
    s_xor_b32 s30, s42, s33
    s_mov_b32 m0, s31
    s_mul_i32 s30, s30, 98304
    s_add_u32 s31, s31, 12288
    s_add_u32 s30, s30, s40
    s_add_u32 s42, s42, 1
    buffer_load_dwordx4 v6, s[16:19], s30 offen  lds
    buffer_load_dwordx4 v6, s[16:19], s30 offen offset:1024  lds
    buffer_load_dwordx4 v6, s[16:19], s30 offen offset:2048  lds
    s_cmp_eq_u32 s42, 8
    s_cselect_b32 s37, 98304, 0
L_k1_pad5:
    s_cbranch_execz L_k1_pad13
    s_sub_u32 s31, s31, s37
L_k1_ld:
    s_waitcnt vmcnt(12)
    s_barrier
    s_xor_b32 s30, s42, s33
    s_mov_b32 m0, s31
    s_mul_i32 s30, s30, 98304
    s_add_u32 s31, s31, 12288
    s_add_u32 s30, s30, s40
    s_add_u32 s42, s42, 1
    buffer_load_dwordx4 v6, s[16:19], s30 offen  lds
    buffer_load_dwordx4 v6, s[16:19], s30 offen offset:1024  lds
    buffer_load_dwordx4 v6, s[16:19], s30 offen offset:2048  lds
    s_cmp_eq_u32 s42, 8
    s_cselect_b32 s37, 98304, 0
    s_sub_u32 s31, s31, s37
    s_cmp_lt_u32 s42, 16
    s_cbranch_scc1 L_k1_ld
    s_waitcnt vmcnt(12)
    s_barrier
    s_waitcnt vmcnt(9)
    s_barrier
    s_waitcnt vmcnt(6)
    s_barrier
    s_waitcnt vmcnt(3)
    s_barrier
    s_waitcnt vmcnt(0)
    s_barrier
    s_cmp_ge_u32 s2, 18
    s_cbranch_scc1 L_k1_end
    s_lshl_b32 s37, s2, 2
    s_add_u32 s37, s37, s44
    s_lshl_b32 s37, s37, 10
    s_add_u32 s37, s37, 0xfe0000
    v_and_b32 v2, 63, v0
    v_lshlrev_b32 v2, 4, v2
    v_mov_b32 v16, 0
    v_mov_b32 v17, 0
    v_mov_b32 v18, 0
    v_mov_b32 v19, 0
    s_mov_b32 s20, s8
    s_mov_b32 s21, s9
    s_mov_b32 s22, 0x1600000
    s_mov_b32 s23, 0x00020000
    buffer_store_dwordx4 v[16:19], v2, s[20:23], s37 offen sc1
    s_endpgm
L_k1_compute:
    s_lshl_b32 s37, s26, 2
    s_lshl_b32 s38, s28, 1
    s_add_u32 s37, s37, s38
    s_lshl_b32 s37, s37, 6
    s_lshl_b32 s38, s25, 1
    s_add_u32 s37, s37, s38
    s_add_u32 s37, s37, s27
    s_lshl_b32 s29, s37, 10
    s_mov_b32 s34, 0x3eb8aa3b
    s_add_u32 s35, s29, 0x200000
    s_add_u32 s36, s29, 0x210000
    s_add_u32 s38, s29, 0x400000
    s_add_u32 s37, s29, 0x10000
    s_waitcnt lgkmcnt(0)
    s_barrier
    ds_read_b64_tr_b16 v[96:97], v13 offset:0
    ds_read_b64_tr_b16 v[98:99], v13 offset:256
    ds_read_b64_tr_b16 v[100:101], v13 offset:1024
    ds_read_b64_tr_b16 v[102:103], v13 offset:1280
    ds_read_b64_tr_b16 v[104:105], v13 offset:2048
    ds_read_b64_tr_b16 v[106:107], v13 offset:2304
    ds_read_b128 v[120:123], v9 offset:0
    ds_read_b64_tr_b16 v[108:109], v13 offset:6144
    ds_read_b64_tr_b16 v[110:111], v13 offset:6400
    ds_read_b64_tr_b16 v[112:113], v13 offset:7168
    ds_read_b64_tr_b16 v[114:115], v13 offset:7424
    ds_read_b64_tr_b16 v[116:117], v13 offset:8192
    ds_read_b64_tr_b16 v[118:119], v13 offset:8448
    ds_read_b128 v[124:127], v10 offset:1024
L_k1_loop:
    s_barrier
    s_waitcnt lgkmcnt(7)
    v_mfma_f32_32x32x16_bf16 v[48:63], v[96:99], v[120:123], v[48:63]
    ds_read_b64_tr_b16 v[96:97], v13 offset:12288
    ds_read_b64_tr_b16 v[98:99], v13 offset:12544
    v_mfma_f32_32x32x16_bf16 v[64:79], v[100:103], v[120:123], v[64:79]
    ds_read_b64_tr_b16 v[100:101], v13 offset:13312
    ds_read_b64_tr_b16 v[102:103], v13 offset:13568
    v_mfma_f32_32x32x16_bf16 v[80:95], v[120:123], v[104:107], v[80:95]
    ds_read_b64_tr_b16 v[104:105], v13 offset:14336
    ds_read_b64_tr_b16 v[106:107], v13 offset:14592
    ds_read_b128 v[120:123], v11 offset:2048
    s_waitcnt lgkmcnt(7)
L_k1_pad6:
    s_cbranch_execz L_k1_pad14
    v_mfma_f32_32x32x16_bf16 v[48:63], v[108:111], v[124:127], v[48:63]
    ds_read_b64_tr_b16 v[108:109], v13 offset:18432
    ds_read_b64_tr_b16 v[110:111], v13 offset:18688
    v_mfma_f32_32x32x16_bf16 v[64:79], v[112:115], v[124:127], v[64:79]
    ds_read_b64_tr_b16 v[112:113], v13 offset:19456
    ds_read_b64_tr_b16 v[114:115], v13 offset:19712
    v_mfma_f32_32x32x16_bf16 v[80:95], v[124:127], v[116:119], v[80:95]
    ds_read_b64_tr_b16 v[116:117], v13 offset:20480
    ds_read_b64_tr_b16 v[118:119], v13 offset:20736
    ds_read_b128 v[124:127], v12 offset:3072
    s_barrier
    s_waitcnt lgkmcnt(7)
    v_mfma_f32_32x32x16_bf16 v[48:63], v[96:99], v[120:123], v[48:63]
    ds_read_b64_tr_b16 v[96:97], v13 offset:24576
    ds_read_b64_tr_b16 v[98:99], v13 offset:24832
    v_mfma_f32_32x32x16_bf16 v[64:79], v[100:103], v[120:123], v[64:79]
    ds_read_b64_tr_b16 v[100:101], v13 offset:25600
    ds_read_b64_tr_b16 v[102:103], v13 offset:25856
    v_mfma_f32_32x32x16_bf16 v[80:95], v[120:123], v[104:107], v[80:95]
    ds_read_b64_tr_b16 v[104:105], v13 offset:26624
    ds_read_b64_tr_b16 v[106:107], v13 offset:26880
    ds_read_b128 v[120:123], v9 offset:4096
    s_waitcnt lgkmcnt(7)
    v_mfma_f32_32x32x16_bf16 v[48:63], v[108:111], v[124:127], v[48:63]
    ds_read_b64_tr_b16 v[108:109], v13 offset:30720
    ds_read_b64_tr_b16 v[110:111], v13 offset:30976
    v_mfma_f32_32x32x16_bf16 v[64:79], v[112:115], v[124:127], v[64:79]
    ds_read_b64_tr_b16 v[112:113], v13 offset:31744
    ds_read_b64_tr_b16 v[114:115], v13 offset:32000
    v_mfma_f32_32x32x16_bf16 v[80:95], v[124:127], v[116:119], v[80:95]
    ds_read_b64_tr_b16 v[116:117], v13 offset:32768
    ds_read_b64_tr_b16 v[118:119], v13 offset:33024
    ds_read_b128 v[124:127], v10 offset:5120
    s_barrier
    s_waitcnt lgkmcnt(7)
    v_mfma_f32_32x32x16_bf16 v[48:63], v[96:99], v[120:123], v[48:63]
    ds_read_b64_tr_b16 v[96:97], v13 offset:36864
    ds_read_b64_tr_b16 v[98:99], v13 offset:37120
    v_mfma_f32_32x32x16_bf16 v[64:79], v[100:103], v[120:123], v[64:79]
    ds_read_b64_tr_b16 v[100:101], v13 offset:37888
    ds_read_b64_tr_b16 v[102:103], v13 offset:38144
    v_mfma_f32_32x32x16_bf16 v[80:95], v[120:123], v[104:107], v[80:95]
    ds_read_b64_tr_b16 v[104:105], v13 offset:38912
    ds_read_b64_tr_b16 v[106:107], v13 offset:39168
    ds_read_b128 v[120:123], v11 offset:6144
    s_waitcnt lgkmcnt(7)
    v_mfma_f32_32x32x16_bf16 v[48:63], v[108:111], v[124:127], v[48:63]
    ds_read_b64_tr_b16 v[108:109], v13 offset:43008
    ds_read_b64_tr_b16 v[110:111], v13 offset:43264
    v_mfma_f32_32x32x16_bf16 v[64:79], v[112:115], v[124:127], v[64:79]
    ds_read_b64_tr_b16 v[112:113], v13 offset:44032
    ds_read_b64_tr_b16 v[114:115], v13 offset:44288
    v_mfma_f32_32x32x16_bf16 v[80:95], v[124:127], v[116:119], v[80:95]
    ds_read_b64_tr_b16 v[116:117], v13 offset:45056
    ds_read_b64_tr_b16 v[118:119], v13 offset:45312
    ds_read_b128 v[124:127], v12 offset:7168
    s_barrier
    s_waitcnt lgkmcnt(7)
    v_mfma_f32_32x32x16_bf16 v[48:63], v[96:99], v[120:123], v[48:63]
    ds_read_b64_tr_b16 v[96:97], v14 offset:0
    ds_read_b64_tr_b16 v[98:99], v14 offset:256
    v_mfma_f32_32x32x16_bf16 v[64:79], v[100:103], v[120:123], v[64:79]
    ds_read_b64_tr_b16 v[100:101], v14 offset:1024
    ds_read_b64_tr_b16 v[102:103], v14 offset:1280
    v_mfma_f32_32x32x16_bf16 v[80:95], v[120:123], v[104:107], v[80:95]
    ds_read_b64_tr_b16 v[104:105], v14 offset:2048
    ds_read_b64_tr_b16 v[106:107], v14 offset:2304
    ds_read_b128 v[120:123], v9 offset:8192
L_k1_pad7:
    s_cbranch_execz L_k1_pad15
    s_waitcnt lgkmcnt(7)
    v_mfma_f32_32x32x16_bf16 v[48:63], v[108:111], v[124:127], v[48:63]
    ds_read_b64_tr_b16 v[108:109], v14 offset:6144
    ds_read_b64_tr_b16 v[110:111], v14 offset:6400
    v_mfma_f32_32x32x16_bf16 v[64:79], v[112:115], v[124:127], v[64:79]
    ds_read_b64_tr_b16 v[112:113], v14 offset:7168
    ds_read_b64_tr_b16 v[114:115], v14 offset:7424
    v_mfma_f32_32x32x16_bf16 v[80:95], v[124:127], v[116:119], v[80:95]
    ds_read_b64_tr_b16 v[116:117], v14 offset:8192
    ds_read_b64_tr_b16 v[118:119], v14 offset:8448
    ds_read_b128 v[124:127], v10 offset:9216
    s_barrier
    s_waitcnt lgkmcnt(7)
    v_mfma_f32_32x32x16_bf16 v[48:63], v[96:99], v[120:123], v[48:63]
    ds_read_b64_tr_b16 v[96:97], v14 offset:12288
    ds_read_b64_tr_b16 v[98:99], v14 offset:12544
    v_mfma_f32_32x32x16_bf16 v[64:79], v[100:103], v[120:123], v[64:79]
    ds_read_b64_tr_b16 v[100:101], v14 offset:13312
    ds_read_b64_tr_b16 v[102:103], v14 offset:13568
    v_mfma_f32_32x32x16_bf16 v[80:95], v[120:123], v[104:107], v[80:95]
    ds_read_b64_tr_b16 v[104:105], v14 offset:14336
    ds_read_b64_tr_b16 v[106:107], v14 offset:14592
    ds_read_b128 v[120:123], v11 offset:10240
    s_waitcnt lgkmcnt(7)
    v_mfma_f32_32x32x16_bf16 v[48:63], v[108:111], v[124:127], v[48:63]
    ds_read_b64_tr_b16 v[108:109], v14 offset:18432
    ds_read_b64_tr_b16 v[110:111], v14 offset:18688
    v_mfma_f32_32x32x16_bf16 v[64:79], v[112:115], v[124:127], v[64:79]
    ds_read_b64_tr_b16 v[112:113], v14 offset:19456
    ds_read_b64_tr_b16 v[114:115], v14 offset:19712
    v_mfma_f32_32x32x16_bf16 v[80:95], v[124:127], v[116:119], v[80:95]
    ds_read_b64_tr_b16 v[116:117], v14 offset:20480
    ds_read_b64_tr_b16 v[118:119], v14 offset:20736
    ds_read_b128 v[124:127], v12 offset:11264
    s_barrier
    s_waitcnt lgkmcnt(7)
    v_mfma_f32_32x32x16_bf16 v[48:63], v[96:99], v[120:123], v[48:63]
    ds_read_b64_tr_b16 v[96:97], v14 offset:24576
    ds_read_b64_tr_b16 v[98:99], v14 offset:24832
    v_mfma_f32_32x32x16_bf16 v[64:79], v[100:103], v[120:123], v[64:79]
    ds_read_b64_tr_b16 v[100:101], v14 offset:25600
    ds_read_b64_tr_b16 v[102:103], v14 offset:25856
    v_mfma_f32_32x32x16_bf16 v[80:95], v[120:123], v[104:107], v[80:95]
    ds_read_b64_tr_b16 v[104:105], v14 offset:26624
    ds_read_b64_tr_b16 v[106:107], v14 offset:26880
    ds_read_b128 v[120:123], v9 offset:12288
    s_waitcnt lgkmcnt(7)
    v_mfma_f32_32x32x16_bf16 v[48:63], v[108:111], v[124:127], v[48:63]
    ds_read_b64_tr_b16 v[108:109], v14 offset:30720
    ds_read_b64_tr_b16 v[110:111], v14 offset:30976
    v_mfma_f32_32x32x16_bf16 v[64:79], v[112:115], v[124:127], v[64:79]
    ds_read_b64_tr_b16 v[112:113], v14 offset:31744
    ds_read_b64_tr_b16 v[114:115], v14 offset:32000
    v_mfma_f32_32x32x16_bf16 v[80:95], v[124:127], v[116:119], v[80:95]
    ds_read_b64_tr_b16 v[116:117], v14 offset:32768
    ds_read_b64_tr_b16 v[118:119], v14 offset:33024
    ds_read_b128 v[124:127], v10 offset:13312
    s_barrier
    s_waitcnt lgkmcnt(7)
    v_mfma_f32_32x32x16_bf16 v[48:63], v[96:99], v[120:123], v[48:63]
    ds_read_b64_tr_b16 v[96:97], v14 offset:36864
    ds_read_b64_tr_b16 v[98:99], v14 offset:37120
    v_mfma_f32_32x32x16_bf16 v[64:79], v[100:103], v[120:123], v[64:79]
    ds_read_b64_tr_b16 v[100:101], v14 offset:37888
    ds_read_b64_tr_b16 v[102:103], v14 offset:38144
    v_mfma_f32_32x32x16_bf16 v[80:95], v[120:123], v[104:107], v[80:95]
    ds_read_b64_tr_b16 v[104:105], v14 offset:38912
    ds_read_b64_tr_b16 v[106:107], v14 offset:39168
L_k1_pad8:
    s_cbranch_execz L_k1_wret
    ds_read_b128 v[120:123], v11 offset:14336
    s_waitcnt lgkmcnt(7)
    v_mfma_f32_32x32x16_bf16 v[48:63], v[108:111], v[124:127], v[48:63]
    ds_read_b64_tr_b16 v[108:109], v14 offset:43008
    ds_read_b64_tr_b16 v[110:111], v14 offset:43264
    v_mfma_f32_32x32x16_bf16 v[64:79], v[112:115], v[124:127], v[64:79]
    ds_read_b64_tr_b16 v[112:113], v14 offset:44032
    ds_read_b64_tr_b16 v[114:115], v14 offset:44288
    v_mfma_f32_32x32x16_bf16 v[80:95], v[124:127], v[116:119], v[80:95]
    ds_read_b64_tr_b16 v[116:117], v14 offset:45056
    ds_read_b64_tr_b16 v[118:119], v14 offset:45312
    ds_read_b128 v[124:127], v12 offset:15360
    s_cmp_eq_u32 s32, 1
    s_cbranch_scc1 L_k1_last
    s_barrier
    s_waitcnt lgkmcnt(7)
    v_mfma_f32_32x32x16_bf16 v[48:63], v[96:99], v[120:123], v[48:63]
    ds_read_b64_tr_b16 v[96:97], v13 offset:0
    ds_read_b64_tr_b16 v[98:99], v13 offset:256
    v_mfma_f32_32x32x16_bf16 v[64:79], v[100:103], v[120:123], v[64:79]
    ds_read_b64_tr_b16 v[100:101], v13 offset:1024
    ds_read_b64_tr_b16 v[102:103], v13 offset:1280
    v_mfma_f32_32x32x16_bf16 v[80:95], v[120:123], v[104:107], v[80:95]
    ds_read_b64_tr_b16 v[104:105], v13 offset:2048
    ds_read_b64_tr_b16 v[106:107], v13 offset:2304
    ds_read_b128 v[120:123], v9 offset:16384
    s_waitcnt lgkmcnt(7)
    v_mfma_f32_32x32x16_bf16 v[48:63], v[108:111], v[124:127], v[48:63]
    ds_read_b64_tr_b16 v[108:109], v13 offset:6144
    ds_read_b64_tr_b16 v[110:111], v13 offset:6400
    v_mfma_f32_32x32x16_bf16 v[64:79], v[112:115], v[124:127], v[64:79]
    ds_read_b64_tr_b16 v[112:113], v13 offset:7168
    ds_read_b64_tr_b16 v[114:115], v13 offset:7424
    v_mfma_f32_32x32x16_bf16 v[80:95], v[124:127], v[116:119], v[80:95]
    ds_read_b64_tr_b16 v[116:117], v13 offset:8192
    ds_read_b64_tr_b16 v[118:119], v13 offset:8448
    ds_read_b128 v[124:127], v10 offset:17408
    v_add_u32 v9, 0x4000, v9
    v_add_u32 v10, 0x4000, v10
    v_add_u32 v11, 0x4000, v11
    v_add_u32 v12, 0x4000, v12
    s_mov_b32 s32, 1
    s_branch L_k1_loop
L_k1_last:
    s_waitcnt lgkmcnt(7)
    v_mfma_f32_32x32x16_bf16 v[48:63], v[96:99], v[120:123], v[48:63]
    v_mfma_f32_32x32x16_bf16 v[64:79], v[100:103], v[120:123], v[64:79]
    v_mfma_f32_32x32x16_bf16 v[80:95], v[120:123], v[104:107], v[80:95]
    s_waitcnt lgkmcnt(0)
    v_mfma_f32_32x32x16_bf16 v[48:63], v[108:111], v[124:127], v[48:63]
    v_mfma_f32_32x32x16_bf16 v[64:79], v[112:115], v[124:127], v[64:79]
    v_mfma_f32_32x32x16_bf16 v[80:95], v[124:127], v[116:119], v[80:95]
    s_nop 7
    s_nop 1
    v_mul_f32 v48, s34, v48
    v_mul_f32 v49, s34, v49
    v_mul_f32 v50, s34, v50
    v_mul_f32 v51, s34, v51
    v_mul_f32 v52, s34, v52
    v_mul_f32 v53, s34, v53
    v_mul_f32 v54, s34, v54
    v_mul_f32 v55, s34, v55
    v_mul_f32 v56, s34, v56
    v_mul_f32 v57, s34, v57
    v_mul_f32 v58, s34, v58
    v_mul_f32 v59, s34, v59
    v_mul_f32 v60, s34, v60
    v_mul_f32 v61, s34, v61
    v_mul_f32 v62, s34, v62
    v_mul_f32 v63, s34, v63
    v_cvt_pk_bf16_f32 v24, v64, v65
    v_cvt_pk_bf16_f32 v25, v66, v67
    v_cvt_pk_bf16_f32 v26, v68, v69
    v_cvt_pk_bf16_f32 v27, v70, v71
    v_cvt_pk_bf16_f32 v28, v72, v73
    v_cvt_pk_bf16_f32 v29, v74, v75
    v_cvt_pk_bf16_f32 v30, v76, v77
    v_cvt_pk_bf16_f32 v31, v78, v79
L_k1_pad9:
    s_cbranch_execz L_k1_wret
    buffer_store_dwordx4 v[24:27], v144, s[20:23], s35 offen sc1
    buffer_store_dwordx4 v[28:31], v144, s[20:23], s36 offen sc1
    v_cvt_pk_bf16_f32 v32, v80, v81
    v_cvt_pk_bf16_f32 v33, v82, v83
    v_cvt_pk_bf16_f32 v34, v84, v85
    v_cvt_pk_bf16_f32 v35, v86, v87
    v_cvt_pk_bf16_f32 v36, v88, v89
    v_cvt_pk_bf16_f32 v37, v90, v91
    v_cvt_pk_bf16_f32 v38, v92, v93
    v_cvt_pk_bf16_f32 v39, v94, v95
    buffer_store_dwordx4 v[32:35], v145, s[20:23], s38 offen sc1
    buffer_store_dwordx4 v[36:39], v145, s[20:23], s38 offen offset:512 sc1
    v_cvt_pk_bf16_f32 v16, v48, v49
    v_cvt_pk_bf16_f32 v17, v50, v51
    v_cvt_pk_bf16_f32 v18, v52, v53
    v_cvt_pk_bf16_f32 v19, v54, v55
    v_cvt_pk_bf16_f32 v20, v56, v57
    v_cvt_pk_bf16_f32 v21, v58, v59
    v_cvt_pk_bf16_f32 v22, v60, v61
    v_cvt_pk_bf16_f32 v23, v62, v63
    buffer_store_dwordx4 v[16:19], v144, s[20:23], s29 offen sc1
    buffer_store_dwordx4 v[20:23], v144, s[20:23], s37 offen sc1
L_k1_end:
    s_endpgm
.globl main_kernel
.p2align 9
.type main_kernel,@function
main_kernel:
L_k1_pad10:
    s_cbranch_execz L_k1_wret
    s_cmp_ge_u32 s2, 256
    s_cbranch_scc1 L_k2_end
    s_load_dwordx2 s[8:9], s[0:1], 72
    s_load_dwordx16 s[32:47], s[0:1], 0
    v_lshrrev_b32 v2, 6, v0
    v_and_b32 v1, 63, v0
    s_and_b32 s22, s2, 7
    v_readfirstlane_b32 s16, v2
    s_lshr_b32 s23, s2, 3
    s_lshl_b32 s17, s22, 2
    s_and_b32 s22, s23, 3
    s_add_u32 s17, s17, s22
    s_lshr_b32 s18, s23, 2
    v_lshlrev_b32 v4, 4, v1
    s_and_b32 s19, s16, 3
    s_lshr_b32 s20, s16, 2
    s_cmp_eq_u32 s16, 8
    s_cbranch_scc1 L_k2_svc
    s_cmp_ge_u32 s16, 9
    s_cbranch_scc1 L_k2_warm
    s_lshl_b32 s22, s17, 16
    s_lshl_b32 s21, s18, 13
    s_add_u32 s22, s22, s21
    s_lshl_b32 s21, s19, 11
    s_add_u32 s22, s22, s21
    s_movk_i32 s24, 35
    s_lshl_b32 s23, s17, 16
    s_lshl_b32 s21, s20, 15
    s_add_u32 s23, s23, s21
    s_add_u32 s23, s23, 0x200000
    s_waitcnt lgkmcnt(0)
    s_mov_b32 s12, s8
    s_mov_b32 s13, s9
    s_mov_b32 s14, 0x1600000
    s_mov_b32 s15, 0x00020000
    buffer_load_dwordx4 v[128:131], v4, s[12:15], s23 offen
    buffer_load_dwordx4 v[16:19], v4, s[12:15], s22 offen
    buffer_load_dwordx4 v[20:23], v4, s[12:15], s22 offen offset:1024
    s_mov_b64 s[58:59], s[32:33]
    s_mov_b64 s[60:61], s[46:47]
    v_mov_b32 v12, 0x3f803f80
    v_and_b32 v2, 22, v0
    v_cmp_eq_u32 vcc, 0, v2
    v_lshlrev_b32 v2, 3, v0
    s_nop 0
    v_cndmask_b32 v12, 0, v12, vcc
    v_mov_b32 v13, v12
    v_add_u32 v2, 0x20000, v2
    ds_write_b64 v2, v[12:13]
    s_lshl_b32 s22, s20, 15
    v_add_u32 v8, s22, v4
    v_and_b32 v2, 15, v1
    v_lshlrev_b32 v2, 4, v2
    v_lshrrev_b32 v3, 5, v1
    v_lshl_add_u32 v3, v3, 8, v2
    s_add_u32 s22, s22, 0x10000
    v_add_u32 v3, s22, v3
    v_add_u32 v2, 0x1fc00, v2
    v_and_b32 v7, 16, v1
    v_cmp_eq_u32 vcc, 0, v7
    v_mov_b32 v7, 0x1000
    s_mov_b32 s25, 0
    v_cndmask_b32 v9, v2, v3, vcc
    v_cndmask_b32 v7, 0, v7, vcc
    v_add_u32 v2, 1024, v2
    v_cndmask_b32 v10, v2, v3, vcc
    v_mov_b32 v88, 0
    v_mov_b32 v89, 0
    v_mov_b32 v90, 0
    v_mov_b32 v91, 0
    v_mov_b32 v92, 0
    v_mov_b32 v93, 0
    v_mov_b32 v94, 0
    v_mov_b32 v95, 0
    v_mov_b32 v96, 0
    v_mov_b32 v97, 0
    v_mov_b32 v98, 0
    v_mov_b32 v99, 0
    v_mov_b32 v100, 0
    v_mov_b32 v101, 0
    v_mov_b32 v102, 0
    v_mov_b32 v103, 0
    v_mov_b32 v104, 0
    v_mov_b32 v105, 0
    v_mov_b32 v106, 0
    v_mov_b32 v107, 0
    v_mov_b32 v108, 0
    v_mov_b32 v109, 0
    v_mov_b32 v110, 0
    v_mov_b32 v111, 0
    v_mov_b32 v112, 0
    v_mov_b32 v113, 0
    v_mov_b32 v114, 0
    v_mov_b32 v115, 0
    v_mov_b32 v116, 0
    v_mov_b32 v117, 0
    v_mov_b32 v118, 0
    v_mov_b32 v119, 0
    v_mov_b32 v124, 0
    v_mov_b32 v125, 0
    v_mov_b32 v126, 0
    v_mov_b32 v127, 0
    v_mov_b32 v148, 0
    v_mov_b32 v149, 0
    v_mov_b32 v150, 0
    v_mov_b32 v151, 0
    s_waitcnt vmcnt(0) lgkmcnt(0)
    v_mfma_f32_32x32x16_bf16 v[56:71], v[128:131], v[16:19], 0
    v_mfma_f32_32x32x16_bf16 v[72:87], v[128:131], v[20:23], 0
L_k1_pad11:
    s_cbranch_execz L_k1_wret
    s_nop 7
    s_nop 3
    v_max3_f32 v152, v56, v57, v58
    v_max3_f32 v152, v152, v59, v60
    v_max3_f32 v152, v152, v61, v62
    v_max3_f32 v152, v152, v63, v64
    v_max3_f32 v152, v152, v65, v66
    v_max3_f32 v152, v152, v67, v68
    v_max3_f32 v152, v152, v69, v70
    v_max_f32 v152, v152, v71
    v_max3_f32 v153, v72, v73, v74
    v_max3_f32 v153, v153, v75, v76
    v_max3_f32 v153, v153, v77, v78
    v_max3_f32 v153, v153, v79, v80
    v_max3_f32 v153, v153, v81, v82
    v_max3_f32 v153, v153, v83, v84
    v_max3_f32 v153, v153, v85, v86
    v_max_f32 v153, v153, v87
    v_mov_b32 v2, v152
    s_nop 1
    v_permlane32_swap_b32 v152, v2
    s_nop 1
    v_max_f32 v152, v152, v2
    v_mov_b32 v3, v153
    s_nop 1
    v_permlane32_swap_b32 v153, v3
    s_nop 1
    v_max_f32 v153, v153, v3
L_k2_start:
    v_mov_b32 v5, v8
    v_mov_b32 v6, v9
    s_barrier
    ds_read_b128 v[136:139], v10
    ds_read_b128 v[140:143], v10 offset:512
    v_sub_f32 v24, 0, v152
    v_sub_f32 v25, 0, v152
    v_sub_f32 v26, 0, v152
    v_sub_f32 v27, 0, v152
    v_sub_f32 v28, 0, v152
    v_sub_f32 v29, 0, v152
    v_sub_f32 v30, 0, v152
    v_sub_f32 v31, 0, v152
    v_sub_f32 v32, 0, v152
    v_sub_f32 v33, 0, v152
    v_sub_f32 v34, 0, v152
    v_sub_f32 v35, 0, v152
    v_sub_f32 v36, 0, v152
    v_sub_f32 v37, 0, v152
    v_sub_f32 v38, 0, v152
    v_sub_f32 v39, 0, v152
    s_mov_b32 s21, 0
    s_nop 0
    v_mfma_f32_32x32x16_bf16 v[56:71], v[128:131], v[16:19], v[24:39]
    v_sub_f32 v40, 0, v153
    v_sub_f32 v41, 0, v153
    v_sub_f32 v42, 0, v153
    v_sub_f32 v43, 0, v153
    v_sub_f32 v44, 0, v153
    v_sub_f32 v45, 0, v153
    v_sub_f32 v46, 0, v153
    v_sub_f32 v47, 0, v153
    v_sub_f32 v48, 0, v153
    v_sub_f32 v49, 0, v153
    v_sub_f32 v50, 0, v153
    v_sub_f32 v51, 0, v153
    v_sub_f32 v52, 0, v153
    v_sub_f32 v53, 0, v153
    v_sub_f32 v54, 0, v153
    v_sub_f32 v55, 0, v153
    s_waitcnt lgkmcnt(0)
L_k2_loop:
    v_exp_f32 v56, v56
    v_exp_f32 v57, v57
    v_mfma_f32_32x32x16_bf16 v[104:119], v[148:151], v[124:127], v[104:119]
    ds_read_b128 v[132:135], v5 offset:1024
    ds_read_b128 v[144:147], v6 offset:1024
    ds_read_b128 v[148:151], v6 offset:1536
    v_exp_f32 v58, v58
    v_exp_f32 v59, v59
    v_cvt_pk_bf16_f32 v120, v56, v57
    v_cvt_pk_bf16_f32 v121, v58, v59
    v_exp_f32 v60, v60
    v_exp_f32 v61, v61
    v_mfma_f32_32x32x16_bf16 v[72:87], v[128:131], v[20:23], v[40:55]
    v_exp_f32 v62, v62
    v_exp_f32 v63, v63
    v_cvt_pk_bf16_f32 v122, v60, v61
    v_cvt_pk_bf16_f32 v123, v62, v63
    v_exp_f32 v64, v64
    v_exp_f32 v65, v65
    v_exp_f32 v66, v66
    v_mfma_f32_32x32x16_bf16 v[88:103], v[136:139], v[120:123], v[88:103]
    v_exp_f32 v67, v67
    v_cvt_pk_bf16_f32 v124, v64, v65
    v_cvt_pk_bf16_f32 v125, v66, v67
    v_exp_f32 v68, v68
    v_exp_f32 v69, v69
    v_exp_f32 v70, v70
    v_exp_f32 v71, v71
    v_cvt_pk_bf16_f32 v126, v68, v69
    v_cvt_pk_bf16_f32 v127, v70, v71
    v_exp_f32 v72, v72
    v_exp_f32 v73, v73
    v_mfma_f32_32x32x16_bf16 v[88:103], v[140:143], v[124:127], v[88:103]
    v_exp_f32 v74, v74
    v_exp_f32 v75, v75
    v_cvt_pk_bf16_f32 v120, v72, v73
    v_cvt_pk_bf16_f32 v121, v74, v75
    v_exp_f32 v76, v76
    v_exp_f32 v77, v77
    s_waitcnt lgkmcnt(0)
    v_mfma_f32_32x32x16_bf16 v[56:71], v[132:135], v[16:19], v[24:39]
    v_exp_f32 v78, v78
    v_exp_f32 v79, v79
    v_cvt_pk_bf16_f32 v122, v76, v77
    v_cvt_pk_bf16_f32 v123, v78, v79
    v_exp_f32 v80, v80
    v_exp_f32 v81, v81
    v_exp_f32 v82, v82
    v_mfma_f32_32x32x16_bf16 v[104:119], v[136:139], v[120:123], v[104:119]
    v_exp_f32 v83, v83
    v_cvt_pk_bf16_f32 v124, v80, v81
    v_cvt_pk_bf16_f32 v125, v82, v83
    v_exp_f32 v84, v84
    v_exp_f32 v85, v85
    v_exp_f32 v86, v86
    v_exp_f32 v87, v87
    v_cvt_pk_bf16_f32 v126, v84, v85
    v_cvt_pk_bf16_f32 v127, v86, v87
    v_exp_f32 v56, v56
    v_exp_f32 v57, v57
    v_mfma_f32_32x32x16_bf16 v[104:119], v[140:143], v[124:127], v[104:119]
    ds_read_b128 v[128:131], v5 offset:2048
    ds_read_b128 v[136:139], v6 offset:2048
    ds_read_b128 v[140:143], v6 offset:2560
    v_exp_f32 v58, v58
    v_exp_f32 v59, v59
    v_cvt_pk_bf16_f32 v120, v56, v57
    v_cvt_pk_bf16_f32 v121, v58, v59
    v_exp_f32 v60, v60
    v_exp_f32 v61, v61
    v_mfma_f32_32x32x16_bf16 v[72:87], v[132:135], v[20:23], v[40:55]
    v_exp_f32 v62, v62
    v_exp_f32 v63, v63
    v_cvt_pk_bf16_f32 v122, v60, v61
    v_cvt_pk_bf16_f32 v123, v62, v63
    v_exp_f32 v64, v64
    v_exp_f32 v65, v65
    v_exp_f32 v66, v66
    v_mfma_f32_32x32x16_bf16 v[88:103], v[144:147], v[120:123], v[88:103]
    v_exp_f32 v67, v67
    v_cvt_pk_bf16_f32 v124, v64, v65
    v_cvt_pk_bf16_f32 v125, v66, v67
    v_exp_f32 v68, v68
    v_exp_f32 v69, v69
    v_exp_f32 v70, v70
    v_exp_f32 v71, v71
    v_cvt_pk_bf16_f32 v126, v68, v69
    v_cvt_pk_bf16_f32 v127, v70, v71
    v_exp_f32 v72, v72
    v_exp_f32 v73, v73
    v_mfma_f32_32x32x16_bf16 v[88:103], v[148:151], v[124:127], v[88:103]
    v_exp_f32 v74, v74
    v_exp_f32 v75, v75
    v_cvt_pk_bf16_f32 v120, v72, v73
    v_cvt_pk_bf16_f32 v121, v74, v75
    v_exp_f32 v76, v76
    v_exp_f32 v77, v77
    s_waitcnt lgkmcnt(0)
    v_mfma_f32_32x32x16_bf16 v[56:71], v[128:131], v[16:19], v[24:39]
    v_exp_f32 v78, v78
    v_exp_f32 v79, v79
    v_cvt_pk_bf16_f32 v122, v76, v77
    v_cvt_pk_bf16_f32 v123, v78, v79
    v_exp_f32 v80, v80
    v_exp_f32 v81, v81
    v_exp_f32 v82, v82
    v_mfma_f32_32x32x16_bf16 v[104:119], v[144:147], v[120:123], v[104:119]
    v_exp_f32 v83, v83
    v_cvt_pk_bf16_f32 v124, v80, v81
    v_cvt_pk_bf16_f32 v125, v82, v83
    v_exp_f32 v84, v84
    v_exp_f32 v85, v85
    v_exp_f32 v86, v86
    v_exp_f32 v87, v87
    v_cvt_pk_bf16_f32 v126, v84, v85
    v_cvt_pk_bf16_f32 v127, v86, v87
    v_exp_f32 v56, v56
    v_exp_f32 v57, v57
    v_mfma_f32_32x32x16_bf16 v[104:119], v[148:151], v[124:127], v[104:119]
    ds_read_b128 v[132:135], v5 offset:3072
    ds_read_b128 v[144:147], v6 offset:3072
    ds_read_b128 v[148:151], v6 offset:3584
    v_exp_f32 v58, v58
    v_exp_f32 v59, v59
    v_cvt_pk_bf16_f32 v120, v56, v57
    v_cvt_pk_bf16_f32 v121, v58, v59
    v_exp_f32 v60, v60
    v_exp_f32 v61, v61
    v_mfma_f32_32x32x16_bf16 v[72:87], v[128:131], v[20:23], v[40:55]
    v_exp_f32 v62, v62
    v_exp_f32 v63, v63
    v_cvt_pk_bf16_f32 v122, v60, v61
    v_cvt_pk_bf16_f32 v123, v62, v63
    v_exp_f32 v64, v64
    v_exp_f32 v65, v65
    v_exp_f32 v66, v66
    v_mfma_f32_32x32x16_bf16 v[88:103], v[136:139], v[120:123], v[88:103]
    v_exp_f32 v67, v67
    v_cvt_pk_bf16_f32 v124, v64, v65
    v_cvt_pk_bf16_f32 v125, v66, v67
    v_exp_f32 v68, v68
    v_exp_f32 v69, v69
    v_exp_f32 v70, v70
    v_exp_f32 v71, v71
    v_cvt_pk_bf16_f32 v126, v68, v69
    v_cvt_pk_bf16_f32 v127, v70, v71
    v_exp_f32 v72, v72
    v_exp_f32 v73, v73
    v_mfma_f32_32x32x16_bf16 v[88:103], v[140:143], v[124:127], v[88:103]
    v_exp_f32 v74, v74
    v_exp_f32 v75, v75
    v_cvt_pk_bf16_f32 v120, v72, v73
    v_cvt_pk_bf16_f32 v121, v74, v75
    v_exp_f32 v76, v76
    v_exp_f32 v77, v77
    s_waitcnt lgkmcnt(0)
    v_mfma_f32_32x32x16_bf16 v[56:71], v[132:135], v[16:19], v[24:39]
    v_exp_f32 v78, v78
    v_exp_f32 v79, v79
    v_cvt_pk_bf16_f32 v122, v76, v77
    v_cvt_pk_bf16_f32 v123, v78, v79
    v_exp_f32 v80, v80
    v_exp_f32 v81, v81
    v_exp_f32 v82, v82
    v_mfma_f32_32x32x16_bf16 v[104:119], v[136:139], v[120:123], v[104:119]
    v_exp_f32 v83, v83
    v_cvt_pk_bf16_f32 v124, v80, v81
    v_cvt_pk_bf16_f32 v125, v82, v83
    v_exp_f32 v84, v84
    v_exp_f32 v85, v85
    v_exp_f32 v86, v86
    v_exp_f32 v87, v87
    v_cvt_pk_bf16_f32 v126, v84, v85
    v_cvt_pk_bf16_f32 v127, v86, v87
    v_exp_f32 v56, v56
    v_exp_f32 v57, v57
    v_mfma_f32_32x32x16_bf16 v[104:119], v[140:143], v[124:127], v[104:119]
    s_bitcmp1_b32 s24, s21
    s_cbranch_scc0 L_k2_syncback
    s_barrier
L_k2_syncback:
    ds_read_b128 v[128:131], v5 offset:4096
    ds_read_b128 v[136:139], v6 offset:4096
    ds_read_b128 v[140:143], v6 offset:4608
    v_exp_f32 v58, v58
    v_exp_f32 v59, v59
    v_cvt_pk_bf16_f32 v120, v56, v57
    v_cvt_pk_bf16_f32 v121, v58, v59
    v_exp_f32 v60, v60
    v_exp_f32 v61, v61
    v_mfma_f32_32x32x16_bf16 v[72:87], v[132:135], v[20:23], v[40:55]
    v_exp_f32 v62, v62
    v_exp_f32 v63, v63
    v_cvt_pk_bf16_f32 v122, v60, v61
    v_cvt_pk_bf16_f32 v123, v62, v63
    v_exp_f32 v64, v64
    v_exp_f32 v65, v65
    v_exp_f32 v66, v66
    v_mfma_f32_32x32x16_bf16 v[88:103], v[144:147], v[120:123], v[88:103]
    v_exp_f32 v67, v67
    v_cvt_pk_bf16_f32 v124, v64, v65
    v_cvt_pk_bf16_f32 v125, v66, v67
    v_exp_f32 v68, v68
    v_exp_f32 v69, v69
    v_exp_f32 v70, v70
    v_exp_f32 v71, v71
    v_cvt_pk_bf16_f32 v126, v68, v69
    v_cvt_pk_bf16_f32 v127, v70, v71
    v_exp_f32 v72, v72
    v_exp_f32 v73, v73
    v_mfma_f32_32x32x16_bf16 v[88:103], v[148:151], v[124:127], v[88:103]
    v_exp_f32 v74, v74
    v_exp_f32 v75, v75
    v_cvt_pk_bf16_f32 v120, v72, v73
    v_cvt_pk_bf16_f32 v121, v74, v75
    v_exp_f32 v76, v76
    v_exp_f32 v77, v77
    s_waitcnt lgkmcnt(0)
    v_mfma_f32_32x32x16_bf16 v[56:71], v[128:131], v[16:19], v[24:39]
    v_exp_f32 v78, v78
    v_exp_f32 v79, v79
    v_cvt_pk_bf16_f32 v122, v76, v77
    v_cvt_pk_bf16_f32 v123, v78, v79
    v_exp_f32 v80, v80
    v_exp_f32 v81, v81
    v_exp_f32 v82, v82
    v_mfma_f32_32x32x16_bf16 v[104:119], v[144:147], v[120:123], v[104:119]
    v_exp_f32 v83, v83
    v_cvt_pk_bf16_f32 v124, v80, v81
    v_cvt_pk_bf16_f32 v125, v82, v83
    v_exp_f32 v84, v84
    v_exp_f32 v85, v85
    v_add_u32 v5, 0x1000, v5
    v_add_u32 v6, v7, v6
    s_add_u32 s21, s21, 1
    s_cmp_lt_u32 s21, 8
    v_exp_f32 v86, v86
    v_exp_f32 v87, v87
    v_cvt_pk_bf16_f32 v126, v84, v85
    v_cvt_pk_bf16_f32 v127, v86, v87
    s_cbranch_scc1 L_k2_loop
L_k1_pad12:
    s_cbranch_execz L_k1_wret
    s_nop 1
    v_mfma_f32_32x32x16_bf16 v[104:119], v[148:151], v[124:127], v[104:119]
    s_mul_i32 s22, s16, 2560
    s_add_u32 s22, s22, 0x21000
    s_xor_b32 s23, s16, 4
    s_mul_i32 s23, s23, 2560
    s_add_u32 s23, s23, 0x21000
    v_add_u32 v154, s22, v4
    v_add_u32 v155, s23, v4
    v_lshl_add_u32 v2, v1, 2, s22
    v_lshl_add_u32 v3, v1, 2, s23
    s_lshl_b32 s22, s16, 2
    s_add_u32 s22, s22, 0x26000
    v_mov_b32 v156, s22
    s_mov_b32 s23, 0x5f800000
    s_nop 2
    v_cmp_nlt_f32 vcc, v96, s23
    s_mov_b64 s[26:27], vcc
    v_cmp_nlt_f32 vcc, v112, s23
    s_or_b64 s[26:27], s[26:27], vcc
    s_cselect_b32 s22, 1, 0
    v_mov_b32 v12, s22
    ds_write_b32 v156, v12
    s_cmp_eq_u32 s20, 0
    s_cbranch_scc1 L_k2_x0
    ds_write_b128 v154, v[88:91]
    ds_write_b128 v154, v[92:95] offset:1024
    ds_write_b32 v2, v96 offset:2048
    ds_write_b32 v2, v152 offset:2304
    v_mov_b32 v33, v153
    s_nop 1
    v_mov_b32 v24, v104
    v_mov_b32 v25, v105
    v_mov_b32 v26, v106
    v_mov_b32 v27, v107
    v_mov_b32 v28, v108
    v_mov_b32 v29, v109
    v_mov_b32 v30, v110
    v_mov_b32 v31, v111
    v_mov_b32 v32, v112
    s_branch L_k2_x1
L_k2_x0:
    ds_write_b128 v154, v[104:107]
    ds_write_b128 v154, v[108:111] offset:1024
    ds_write_b32 v2, v112 offset:2048
    ds_write_b32 v2, v153 offset:2304
    v_mov_b32 v33, v152
    v_mov_b32 v24, v88
    v_mov_b32 v25, v89
    v_mov_b32 v26, v90
    v_mov_b32 v27, v91
    v_mov_b32 v28, v92
    v_mov_b32 v29, v93
    v_mov_b32 v30, v94
    v_mov_b32 v31, v95
    v_mov_b32 v32, v96
L_k2_x1:
    v_mov_b32 v156, 0x26000
    s_waitcnt lgkmcnt(0)
    s_barrier
    ds_read_b32 v80, v156 offset:8144
    ds_read_b128 v[72:75], v156
L_k1_pad13:
    s_cbranch_execz L_k1_wret
    ds_read_b128 v[76:79], v156 offset:16
    ds_read_b32 v65, v3 offset:2304
    ds_read_b32 v64, v3 offset:2048
    ds_read_b128 v[56:59], v155
    ds_read_b128 v[60:63], v155 offset:1024
    s_lshl_b32 s22, s18, 3
    s_lshl_b32 s23, s19, 1
    s_add_u32 s22, s22, s23
    s_add_u32 s22, s22, s20
    s_and_b32 s21, s22, 7
    s_lshl_b32 s21, s21, 2
    s_lshl_b32 s23, s18, 12
    s_add_u32 s21, s21, s23
    s_lshl_b32 s23, s17, 7
    s_add_u32 s21, s21, s23
    s_add_u32 s21, s21, 0xfea000
    s_lshl_b32 s22, s22, 5
    s_add_u32 s22, s22, s17
    s_lshl_b32 s22, s22, 10
    s_add_u32 s22, s22, 0x600000
    s_waitcnt lgkmcnt(3)
    v_max_f32 v66, v65, v33
    v_or3_b32 v72, v72, v73, v74
    v_sub_f32 v65, v65, v66
    v_sub_f32 v33, v33, v66
    v_or3_b32 v75, v75, v76, v77
    v_exp_f32 v65, v65
    v_exp_f32 v33, v33
    v_or3_b32 v72, v72, v78, v79
    v_or_b32 v72, v72, v75
    s_waitcnt lgkmcnt(2)
    v_readfirstlane_b32 s23, v72
    v_readfirstlane_b32 s57, v80
    v_mul_f32 v64, v64, v65
    v_fma_f32 v64, v32, v33, v64
    v_rcp_f32 v64, v64
    s_andn2_b32 s23, s23, s25
    s_cbranch_scc1 L_k2_fallback
    v_mul_f32 v65, v65, v64
    v_mul_f32 v33, v33, v64
    s_waitcnt lgkmcnt(0)
    v_mul_f32 v56, v56, v65
    v_mul_f32 v57, v57, v65
    v_mul_f32 v58, v58, v65
    v_mul_f32 v59, v59, v65
    v_mul_f32 v60, v60, v65
    v_mul_f32 v61, v61, v65
    v_mul_f32 v62, v62, v65
    v_mul_f32 v63, v63, v65
    v_fma_f32 v56, v24, v33, v56
    v_fma_f32 v57, v25, v33, v57
    v_fma_f32 v58, v26, v33, v58
    v_fma_f32 v59, v27, v33, v59
    v_fma_f32 v60, v28, v33, v60
    v_fma_f32 v61, v29, v33, v61
    v_fma_f32 v62, v30, v33, v62
    v_fma_f32 v63, v31, v33, v63
    v_cvt_pk_bf16_f32 v120, v56, v57
    v_cvt_pk_bf16_f32 v121, v58, v59
    v_cvt_pk_bf16_f32 v122, v60, v61
    v_cvt_pk_bf16_f32 v123, v62, v63
    buffer_store_dwordx4 v[120:123], v4, s[12:15], s22 offen sc1
    v_mov_b32 v2, 0
    v_mov_b32 v3, 1
    s_waitcnt vmcnt(0)
    s_mov_b64 exec, 1
    buffer_store_dword v3, v2, s[12:15], s21 offen sc0 sc1
    s_mov_b64 exec, -1
    s_branch L_post
L_k2_end:
    s_endpgm
L_k2_svc:
    s_setprio 3
    s_lshl_b32 s28, s17, 16
    s_add_u32 s28, s28, 0x200000
    s_mov_b32 s31, 0
    s_mov_b32 s21, 0
    s_waitcnt lgkmcnt(0)
    s_mov_b32 s12, s8
    s_mov_b32 s13, s9
    s_mov_b32 s14, 0x1600000
    s_mov_b32 s15, 0x00020000
    s_add_u32 m0, s31, 0x0
    s_add_u32 s22, s28, 0x0
    buffer_load_dwordx4 v4, s[12:15], s22 offen offset:0 lds
    buffer_load_dwordx4 v4, s[12:15], s22 offen offset:1024 lds
    buffer_load_dwordx4 v4, s[12:15], s22 offen offset:2048 lds
    buffer_load_dwordx4 v4, s[12:15], s22 offen offset:3072 lds
    s_add_u32 m0, s31, 0x8000
    s_add_u32 s22, s28, 0x8000
    buffer_load_dwordx4 v4, s[12:15], s22 offen offset:0 lds
    buffer_load_dwordx4 v4, s[12:15], s22 offen offset:1024 lds
L_k1_pad14:
    s_cbranch_execz L_k1_wret
    buffer_load_dwordx4 v4, s[12:15], s22 offen offset:2048 lds
    buffer_load_dwordx4 v4, s[12:15], s22 offen offset:3072 lds
    s_add_u32 m0, s31, 0x10000
    s_add_u32 s22, s28, 0x200000
    buffer_load_dwordx4 v4, s[12:15], s22 offen offset:0 lds
    buffer_load_dwordx4 v4, s[12:15], s22 offen offset:1024 lds
    buffer_load_dwordx4 v4, s[12:15], s22 offen offset:2048 lds
    buffer_load_dwordx4 v4, s[12:15], s22 offen offset:3072 lds
    s_add_u32 m0, s31, 0x18000
    s_add_u32 s22, s28, 0x208000
    buffer_load_dwordx4 v4, s[12:15], s22 offen offset:0 lds
    buffer_load_dwordx4 v4, s[12:15], s22 offen offset:1024 lds
    buffer_load_dwordx4 v4, s[12:15], s22 offen offset:2048 lds
    buffer_load_dwordx4 v4, s[12:15], s22 offen offset:3072 lds
    s_add_u32 s31, s31, 4096
    s_add_u32 s28, s28, 4096
    s_add_u32 s21, s21, 1
    v_lshrrev_b32 v2, 5, v1
    v_lshlrev_b32 v2, 9, v2
    v_bfe_u32 v3, v1, 2, 2
    v_lshl_add_u32 v2, v3, 6, v2
    v_bfe_u32 v3, v1, 4, 1
    v_lshl_add_u32 v2, v3, 5, v2
    v_and_b32 v3, 1, v1
    v_lshl_add_u32 v2, v3, 4, v2
    v_bfe_u32 v3, v1, 1, 1
    v_lshl_add_u32 v6, v3, 3, v2
    v_add_u32 v6, 0x21000, v6
    v_lshrrev_b32 v2, 2, v1
    v_and_b32 v3, 3, v1
    s_cmp_ge_u32 s2, 172
    s_movk_i32 s23, 2752
    s_cselect_b32 s23, 1024, s23
    v_mul_u32_u24 v2, s23, v2
    v_lshl_add_u32 v5, v3, 4, v2
    v_lshlrev_b32 v56, 7, v1
    v_and_b32 v57, 896, v56
    v_bfe_u32 v2, v1, 4, 1
    v_and_b32 v3, 15, v1
    v_cmp_eq_u32 vcc, v2, v3
    v_mov_b32 v16, 0x3f803f80
    v_lshlrev_b32 v7, 6, v3
    v_cndmask_b32 v16, 0, v16, vcc
    v_lshl_add_u32 v7, v2, 5, v7
    v_lshrrev_b32 v2, 5, v1
    v_lshl_add_u32 v7, v2, 4, v7
    v_mov_b32 v17, v16
    v_mov_b32 v18, v16
    v_mov_b32 v19, v16
    v_mov_b32 v88, 0
    v_mov_b32 v89, 0
    v_mov_b32 v90, 0
    v_mov_b32 v91, 0
    v_and_b32 v58, 384, v56
    v_and_b32 v2, 4, v1
    v_lshl_add_u32 v58, v2, 10, v58
    v_and_b32 v59, 3968, v56
    v_add_u32 v60, 8192, v56
    v_add_u32 v61, 16384, v56
    v_add_u32 v62, 24576, v56
    s_getreg_b32 s22, hwreg(HW_REG_XCC_ID)
    s_and_b32 s22, s22, 15
    s_add_u32 s22, s22, 1
    v_mov_b32 v63, s22
    v_mov_b32 v2, 0
    v_mov_b32 v3, 163776
    ds_write_b32 v3, v2
    ds_write_b32 v3, v2 offset:4
    s_waitcnt vmcnt(0)
    s_barrier
L_k2_grp:
    s_add_u32 m0, s31, 0x0
    s_add_u32 s22, s28, 0x0
    buffer_load_dwordx4 v4, s[12:15], s22 offen offset:0 lds
    buffer_load_dwordx4 v4, s[12:15], s22 offen offset:1024 lds
    buffer_load_dwordx4 v4, s[12:15], s22 offen offset:2048 lds
    buffer_load_dwordx4 v4, s[12:15], s22 offen offset:3072 lds
    s_add_u32 m0, s31, 0x8000
    s_add_u32 s22, s28, 0x8000
    buffer_load_dwordx4 v4, s[12:15], s22 offen offset:0 lds
L_k1_pad15:
    s_cbranch_execz L_k1_wret
    buffer_load_dwordx4 v4, s[12:15], s22 offen offset:1024 lds
    buffer_load_dwordx4 v4, s[12:15], s22 offen offset:2048 lds
    buffer_load_dwordx4 v4, s[12:15], s22 offen offset:3072 lds
    s_add_u32 m0, s31, 0x10000
    s_add_u32 s22, s28, 0x200000
    buffer_load_dwordx4 v4, s[12:15], s22 offen offset:0 lds
    buffer_load_dwordx4 v4, s[12:15], s22 offen offset:1024 lds
    buffer_load_dwordx4 v4, s[12:15], s22 offen offset:2048 lds
    buffer_load_dwordx4 v4, s[12:15], s22 offen offset:3072 lds
    s_add_u32 m0, s31, 0x18000
    s_add_u32 s22, s28, 0x208000
    buffer_load_dwordx4 v4, s[12:15], s22 offen offset:0 lds
    buffer_load_dwordx4 v4, s[12:15], s22 offen offset:1024 lds
    buffer_load_dwordx4 v4, s[12:15], s22 offen offset:2048 lds
    buffer_load_dwordx4 v4, s[12:15], s22 offen offset:3072 lds
    s_add_u32 s31, s31, 4096
    s_add_u32 s28, s28, 4096
    s_add_u32 s21, s21, 1
    s_waitcnt vmcnt(32)
    s_cmp_lg_u32 s21, 4
    s_cbranch_scc1 L_k2_g2
    s_barrier
L_k2_g2:
    s_cmp_lt_u32 s21, 8
    s_cbranch_scc1 L_k2_grp
    s_lshr_b32 s29, s2, 3
    s_and_b32 s30, s2, 7
    s_mov_b32 s51, 0x00020000
    s_waitcnt vmcnt(0)
    s_barrier
    s_cmp_ge_u32 s2, 172
    s_cbranch_scc1 L_k2_jd
    s_lshr_b32 s29, s2, 1
    s_cmp_lt_u32 s29, 43
    s_cselect_b32 s48, s40, s42
    s_cselect_b32 s49, s41, s43
    s_cselect_b32 s22, 0, 43
    s_cselect_b32 s53, 0, 3072
    s_mov_b32 s50, 0x158000
    s_sub_u32 s29, s29, s22
    s_and_b32 s31, s2, 1
    s_mul_i32 s28, s31, 704512
    s_lshl_b32 s22, s29, 6
    s_add_u32 s28, s28, s22
    s_mul_i32 s22, s29, 43
    s_lshr_b32 s22, s22, 7
    s_mul_i32 s23, s22, 193536
    s_add_u32 s53, s53, s23
    s_lshl_b32 s23, s29, 10
    s_add_u32 s53, s53, s23
    s_mul_i32 s23, s31, 98304
    s_add_u32 s53, s53, s23
    s_add_u32 s53, s53, 0x1000000
    s_mov_b32 s52, 44032
    s_movk_i32 s54, 6144
    s_movk_i32 s55, 6144
    s_movk_i32 s56, 200
    s_branch L_k2_job
L_k2_jd:
    s_sub_u32 s56, s2, 172
    s_movk_i32 s52, 64
    s_movk_i32 s54, 1024
L_k2_jd2:
    s_cmp_ge_u32 s56, 32
    s_cbranch_scc1 L_k2_jdd
    s_mov_b32 s48, s36
    s_mov_b32 s49, s37
    s_mov_b32 s50, 0x80000
    s_lshl_b32 s28, s56, 14
    s_lshl_b32 s53, s56, 11
    s_add_u32 s53, s53, 0x1500000
    s_mov_b32 s55, 64512
    s_branch L_k2_job
L_k2_jdd:
    s_mov_b32 s48, s44
    s_mov_b32 s49, s45
    s_mov_b32 s50, 0x158000
    s_sub_u32 s31, s56, 32
    s_lshl_b32 s28, s31, 14
    s_mul_i32 s22, s31, 43
    s_lshr_b32 s22, s22, 8
    s_mul_i32 s23, s22, 6
    s_sub_u32 s23, s31, s23
    s_lshr_b32 s23, s23, 1
    s_mul_i32 s23, s23, 28
    s_lshl_b32 s22, s22, 1
    s_add_u32 s22, s22, s23
    s_add_u32 s22, s22, 4
    s_cmp_ge_u32 s31, 84
    s_cselect_b32 s22, 0, s22
    s_and_b32 s23, s31, 1
    s_add_u32 s22, s22, s23
    s_lshl_b32 s53, s22, 11
    s_add_u32 s53, s53, 0x1300000
    s_mov_b32 s55, 179200
L_k2_job:
    s_mov_b32 m0, 0x21000
    s_mov_b32 s31, 0
L_k2_csd:
    buffer_load_dwordx4 v5, s[48:51], s28 offen lds
    s_add_u32 m0, m0, 1024
    s_add_u32 s28, s28, s52
    s_add_u32 s31, s31, 1
    s_cmp_lt_u32 s31, 16
    s_cbranch_scc1 L_k2_csd
    s_waitcnt vmcnt(0)
    ds_read_b64_tr_b16 v[24:25], v6 offset:0
    ds_read_b64_tr_b16 v[26:27], v6 offset:256
    ds_read_b64_tr_b16 v[28:29], v6 offset:1024
    ds_read_b64_tr_b16 v[30:31], v6 offset:1280
    ds_read_b64_tr_b16 v[32:33], v6 offset:2048
    ds_read_b64_tr_b16 v[34:35], v6 offset:2304
    ds_read_b64_tr_b16 v[36:37], v6 offset:3072
    ds_read_b64_tr_b16 v[38:39], v6 offset:3328
    ds_read_b64_tr_b16 v[40:41], v6 offset:4096
    ds_read_b64_tr_b16 v[42:43], v6 offset:4352
    ds_read_b64_tr_b16 v[44:45], v6 offset:5120
    ds_read_b64_tr_b16 v[46:47], v6 offset:5376
    ds_read_b64_tr_b16 v[48:49], v6 offset:6144
    ds_read_b64_tr_b16 v[50:51], v6 offset:6400
    ds_read_b64_tr_b16 v[52:53], v6 offset:7168
    ds_read_b64_tr_b16 v[54:55], v6 offset:7424
    s_waitcnt lgkmcnt(0)
    buffer_store_dwordx4 v[24:27], v4, s[12:15], s53 offen sc1
    s_add_u32 s53, s53, s54
    s_cmp_lt_u32 s56, 200
    s_cbranch_scc1 L_k2_nocs0_0
    v_mfma_f32_16x16x32_bf16 v[88:91], v[24:27], v[16:19], v[88:91]
L_k2_nocs0_0:
    buffer_store_dwordx4 v[28:31], v4, s[12:15], s53 offen sc1
    s_add_u32 s53, s53, s55
    s_cmp_lt_u32 s56, 200
    s_cbranch_scc1 L_k2_nocs0_1
    v_mfma_f32_16x16x32_bf16 v[88:91], v[28:31], v[16:19], v[88:91]
L_k2_nocs0_1:
    buffer_store_dwordx4 v[32:35], v4, s[12:15], s53 offen sc1
    s_add_u32 s53, s53, s54
    s_cmp_lt_u32 s56, 200
    s_cbranch_scc1 L_k2_nocs0_2
    v_mfma_f32_16x16x32_bf16 v[88:91], v[32:35], v[16:19], v[88:91]
L_k2_nocs0_2:
    buffer_store_dwordx4 v[36:39], v4, s[12:15], s53 offen sc1
    s_add_u32 s53, s53, s55
    s_cmp_lt_u32 s56, 200
    s_cbranch_scc1 L_k2_nocs0_3
    v_mfma_f32_16x16x32_bf16 v[88:91], v[36:39], v[16:19], v[88:91]
L_k2_nocs0_3:
    buffer_store_dwordx4 v[40:43], v4, s[12:15], s53 offen sc1
    s_add_u32 s53, s53, s54
    s_cmp_lt_u32 s56, 200
    s_cbranch_scc1 L_k2_nocs0_4
    v_mfma_f32_16x16x32_bf16 v[88:91], v[40:43], v[16:19], v[88:91]
L_k2_nocs0_4:
    buffer_store_dwordx4 v[44:47], v4, s[12:15], s53 offen sc1
    s_add_u32 s53, s53, s55
    s_cmp_lt_u32 s56, 200
    s_cbranch_scc1 L_k2_nocs0_5
    v_mfma_f32_16x16x32_bf16 v[88:91], v[44:47], v[16:19], v[88:91]
L_k2_nocs0_5:
    buffer_store_dwordx4 v[48:51], v4, s[12:15], s53 offen sc1
    s_add_u32 s53, s53, s54
    s_cmp_lt_u32 s56, 200
    s_cbranch_scc1 L_k2_nocs0_6
    v_mfma_f32_16x16x32_bf16 v[88:91], v[48:51], v[16:19], v[88:91]
L_k2_nocs0_6:
    buffer_store_dwordx4 v[52:55], v4, s[12:15], s53 offen sc1
    s_add_u32 s53, s53, s55
    s_cmp_lt_u32 s56, 200
    s_cbranch_scc1 L_k2_nocs0_7
    v_mfma_f32_16x16x32_bf16 v[88:91], v[52:55], v[16:19], v[88:91]
L_k2_nocs0_7:
    ds_read_b64_tr_b16 v[24:25], v6 offset:8192
    ds_read_b64_tr_b16 v[26:27], v6 offset:8448
    ds_read_b64_tr_b16 v[28:29], v6 offset:9216
    ds_read_b64_tr_b16 v[30:31], v6 offset:9472
    ds_read_b64_tr_b16 v[32:33], v6 offset:10240
    ds_read_b64_tr_b16 v[34:35], v6 offset:10496
    ds_read_b64_tr_b16 v[36:37], v6 offset:11264
    ds_read_b64_tr_b16 v[38:39], v6 offset:11520
    ds_read_b64_tr_b16 v[40:41], v6 offset:12288
    ds_read_b64_tr_b16 v[42:43], v6 offset:12544
    ds_read_b64_tr_b16 v[44:45], v6 offset:13312
    ds_read_b64_tr_b16 v[46:47], v6 offset:13568
    ds_read_b64_tr_b16 v[48:49], v6 offset:14336
    ds_read_b64_tr_b16 v[50:51], v6 offset:14592
    ds_read_b64_tr_b16 v[52:53], v6 offset:15360
    ds_read_b64_tr_b16 v[54:55], v6 offset:15616
    s_waitcnt lgkmcnt(0)
    buffer_store_dwordx4 v[24:27], v4, s[12:15], s53 offen sc1
    s_add_u32 s53, s53, s54
    s_cmp_lt_u32 s56, 200
    s_cbranch_scc1 L_k2_nocs1_0
    v_mfma_f32_16x16x32_bf16 v[88:91], v[24:27], v[16:19], v[88:91]
L_k2_nocs1_0:
    buffer_store_dwordx4 v[28:31], v4, s[12:15], s53 offen sc1
    s_add_u32 s53, s53, s55
    s_cmp_lt_u32 s56, 200
    s_cbranch_scc1 L_k2_nocs1_1
    v_mfma_f32_16x16x32_bf16 v[88:91], v[28:31], v[16:19], v[88:91]
L_k2_nocs1_1:
    buffer_store_dwordx4 v[32:35], v4, s[12:15], s53 offen sc1
    s_add_u32 s53, s53, s54
    s_cmp_lt_u32 s56, 200
    s_cbranch_scc1 L_k2_nocs1_2
    v_mfma_f32_16x16x32_bf16 v[88:91], v[32:35], v[16:19], v[88:91]
L_k2_nocs1_2:
    buffer_store_dwordx4 v[36:39], v4, s[12:15], s53 offen sc1
    s_add_u32 s53, s53, s55
    s_cmp_lt_u32 s56, 200
    s_cbranch_scc1 L_k2_nocs1_3
    v_mfma_f32_16x16x32_bf16 v[88:91], v[36:39], v[16:19], v[88:91]
L_k2_nocs1_3:
    buffer_store_dwordx4 v[40:43], v4, s[12:15], s53 offen sc1
    s_add_u32 s53, s53, s54
    s_cmp_lt_u32 s56, 200
    s_cbranch_scc1 L_k2_nocs1_4
    v_mfma_f32_16x16x32_bf16 v[88:91], v[40:43], v[16:19], v[88:91]
L_k2_nocs1_4:
    buffer_store_dwordx4 v[44:47], v4, s[12:15], s53 offen sc1
    s_add_u32 s53, s53, s55
    s_cmp_lt_u32 s56, 200
    s_cbranch_scc1 L_k2_nocs1_5
    v_mfma_f32_16x16x32_bf16 v[88:91], v[44:47], v[16:19], v[88:91]
L_k2_nocs1_5:
    buffer_store_dwordx4 v[48:51], v4, s[12:15], s53 offen sc1
    s_add_u32 s53, s53, s54
    s_cmp_lt_u32 s56, 200
    s_cbranch_scc1 L_k2_nocs1_6
    v_mfma_f32_16x16x32_bf16 v[88:91], v[48:51], v[16:19], v[88:91]
L_k2_nocs1_6:
    buffer_store_dwordx4 v[52:55], v4, s[12:15], s53 offen sc1
    s_add_u32 s53, s53, s55
    s_cmp_lt_u32 s56, 200
    s_cbranch_scc1 L_k2_nocs1_7
    v_mfma_f32_16x16x32_bf16 v[88:91], v[52:55], v[16:19], v[88:91]
L_k2_nocs1_7:
    s_add_u32 s56, s56, 84
    s_cmp_lt_u32 s56, 118
    s_cbranch_scc1 L_k2_jd2
    s_cmp_lt_u32 s56, 284
    s_cbranch_scc1 L_k2_pf0
    s_cmp_lt_u32 s2, 86
    s_cselect_b32 s22, 0, 8192
    s_lshl_b32 s29, s29, 7
    s_add_u32 s22, s22, s29
    s_and_b32 s31, s2, 1
    s_mul_i32 s31, s31, 16384
    s_add_u32 s22, s22, s31
    s_add_u32 s22, s22, 0xfc0000
    s_mov_b32 s26, 0x00030003
    s_mov_b32 s27, 0x00030003
    s_mov_b64 exec, s[26:27]
    buffer_store_dwordx4 v[88:91], v7, s[12:15], s22 offen sc1
    s_mov_b64 exec, -1
L_k2_pf0:
    s_lshr_b32 s29, s2, 3
    s_lshl_b32 s22, s30, 5
    s_add_u32 s22, s22, s29
    s_lshl_b32 s22, s22, 7
    s_add_u32 s22, s22, 0xfe2000
    s_waitcnt vmcnt(0)
    s_mov_b64 exec, 1
    buffer_store_dword v63, v2, s[12:15], s22 offen sc0 sc1
    s_mov_b64 exec, -1
    s_mov_b32 s48, s8
    s_mov_b32 s49, s9
    s_mov_b32 s50, 0x1600000
    s_lshl_b32 s22, s30, 5
    s_add_u32 s28, s22, s29
    s_mul_i32 s22, s28, 22016
    s_add_u32 s22, s22, 0xa00000
    s_add_u32 s23, s22, 6912
    s_add_u32 s31, s22, 13824
    buffer_load_dword v72, v56, s[48:51], s22 offen
    buffer_load_dword v73, v56, s[48:51], s23 offen
    buffer_load_dword v74, v56, s[48:51], s31 offen
    s_lshl_b32 s28, s28, 13
    s_add_u32 s23, s28, 0x800000
    s_lshr_b32 s22, s28, 3
    s_add_u32 s22, s22, 0xf80000
    buffer_load_dword v75, v56, s[48:51], s23 offen
    buffer_load_dword v76, v57, s[48:51], s22 offen
    s_mov_b32 s48, s32
    s_mov_b32 s49, s33
    s_mov_b32 s50, 0x200000
    buffer_load_dword v77, v56, s[48:51], s28 offen
    s_lshl_b32 s23, s30, 9
    s_add_u32 s23, s23, 0xfe0000
    buffer_load_dword v79, v58, s[12:15], s23 offen
    s_mov_b32 s21, 0
    s_mov_b32 s22, 0xfe2000
    s_lshl_b32 s23, s30, 12
    s_add_u32 s23, s23, 0xfe2000
    s_barrier
L_k2_px:
    buffer_load_dword v84, v56, s[12:15], s22 offen sc1
    buffer_load_dword v85, v60, s[12:15], s22 offen sc1
    buffer_load_dword v86, v61, s[12:15], s22 offen sc1
    buffer_load_dword v87, v62, s[12:15], s22 offen sc1
    s_add_u32 s21, s21, 1
    s_waitcnt vmcnt(0)
    v_min_u32 v84, v84, v85
    v_min3_u32 v84, v84, v86, v87
    s_cmp_ge_u32 s21, 400000
    v_cmp_eq_u32 vcc, 0, v84
    s_cbranch_scc1 L_k2_pxx
    s_cbranch_vccnz L_k2_px
L_k2_pxx:
    buffer_load_dword v84, v59, s[12:15], s23 offen sc1
    s_lshl_b32 s28, s29, 14
    s_add_u32 s28, s28, 0x1500000
    s_add_u32 s31, s28, 8192
    s_lshr_b32 s23, s29, 1
    s_min_u32 s23, s23, 14
    s_mul_i32 s23, s23, 196608
    s_and_b32 s22, s29, 1
    s_mul_i32 s22, s22, 81920
    s_add_u32 s23, s23, s22
    s_add_u32 s23, s23, 0x1000000
    buffer_load_dword v72, v56, s[12:15], s28 offen
    buffer_load_dword v73, v56, s[12:15], s31 offen
    buffer_load_dword v74, v56, s[12:15], s23 offen
    s_add_u32 s23, s23, 8192
    buffer_load_dword v75, v56, s[12:15], s23 offen
    s_add_u32 s23, s23, 8192
    buffer_load_dword v76, v56, s[12:15], s23 offen
    s_add_u32 s23, s23, 8192
    buffer_load_dword v77, v56, s[12:15], s23 offen
    s_add_u32 s23, s23, 8192
    buffer_load_dword v78, v56, s[12:15], s23 offen
    s_add_u32 s23, s23, 8192
    buffer_load_dword v79, v56, s[12:15], s23 offen
    s_add_u32 s23, s23, 8192
    buffer_load_dword v80, v56, s[12:15], s23 offen
    s_add_u32 s23, s23, 8192
    buffer_load_dword v81, v56, s[12:15], s23 offen
    s_add_u32 s23, s23, 8192
    buffer_load_dword v82, v56, s[12:15], s23 offen
    s_add_u32 s23, s23, 8192
    buffer_load_dword v83, v56, s[12:15], s23 offen
    s_add_u32 s23, s23, 8192
    s_waitcnt vmcnt(12)
    v_readfirstlane_b32 s22, v84
    s_nop 1
    v_cmp_ne_u32 vcc, s22, v84
    s_cmp_eq_u64 vcc, 0
    s_cselect_b32 s23, 1, 0
    s_cmp_eq_u32 s22, 0
    s_cselect_b32 s23, 0, s23
    v_mov_b32 v2, s23
    ds_write_b32 v3, v2 offset:16
    s_waitcnt lgkmcnt(0)
    s_barrier
    s_endpgm
L_k2_warm:
    s_barrier
    s_barrier
    s_barrier
    s_mov_b64 exec, 0
    s_cmp_eq_u32 s16, 9
    s_cbranch_scc1 L_w3_pad0
    s_cmp_eq_u32 s16, 10
    s_cbranch_scc1 L_w3_pad1
L_w3_wret:
    s_endpgm
L_k2_fallback:
    s_mov_b32 s25, 1
    s_mov_b32 s24, 0
    s_waitcnt lgkmcnt(0)
    v_mov_b32 v5, v8
    v_mov_b32 v152, 0xff800000
    v_mov_b32 v153, 0xff800000
    s_mov_b32 s21, 0
L_k2_fbloop:
    ds_read_b128 v[128:131], v5
    v_add_u32 v5, 1024, v5
    s_waitcnt lgkmcnt(0)
    v_mfma_f32_32x32x16_bf16 v[56:71], v[128:131], v[16:19], 0
    v_mfma_f32_32x32x16_bf16 v[72:87], v[128:131], v[20:23], 0
    s_nop 7
    s_nop 3
    v_max3_f32 v152, v152, v56, v57
    v_max3_f32 v152, v152, v58, v59
    v_max3_f32 v152, v152, v60, v61
    v_max3_f32 v152, v152, v62, v63
    v_max3_f32 v152, v152, v64, v65
    v_max3_f32 v152, v152, v66, v67
    v_max3_f32 v152, v152, v68, v69
    v_max3_f32 v152, v152, v70, v71
    v_max3_f32 v153, v153, v72, v73
    v_max3_f32 v153, v153, v74, v75
    v_max3_f32 v153, v153, v76, v77
    v_max3_f32 v153, v153, v78, v79
    v_max3_f32 v153, v153, v80, v81
    v_max3_f32 v153, v153, v82, v83
    v_max3_f32 v153, v153, v84, v85
    v_max3_f32 v153, v153, v86, v87
    s_add_u32 s21, s21, 1
    s_cmp_lt_u32 s21, 32
    s_cbranch_scc1 L_k2_fbloop
    v_mov_b32 v2, v152
    s_nop 1
    v_permlane32_swap_b32 v152, v2
    s_nop 1
    v_max_f32 v152, v152, v2
    v_mov_b32 v3, v153
    s_nop 1
    v_permlane32_swap_b32 v153, v3
    s_nop 1
    v_max_f32 v153, v153, v3
    ds_read_b128 v[128:131], v8
    s_waitcnt lgkmcnt(0)
    v_mov_b32 v88, 0
    v_mov_b32 v89, 0
    v_mov_b32 v90, 0
    v_mov_b32 v91, 0
    v_mov_b32 v92, 0
    v_mov_b32 v93, 0
    v_mov_b32 v94, 0
    v_mov_b32 v95, 0
    v_mov_b32 v96, 0
    v_mov_b32 v97, 0
    v_mov_b32 v98, 0
    v_mov_b32 v99, 0
    v_mov_b32 v100, 0
    v_mov_b32 v101, 0
    v_mov_b32 v102, 0
    v_mov_b32 v103, 0
    v_mov_b32 v104, 0
    v_mov_b32 v105, 0
    v_mov_b32 v106, 0
    v_mov_b32 v107, 0
    v_mov_b32 v108, 0
    v_mov_b32 v109, 0
    v_mov_b32 v110, 0
    v_mov_b32 v111, 0
    v_mov_b32 v112, 0
    v_mov_b32 v113, 0
    v_mov_b32 v114, 0
    v_mov_b32 v115, 0
    v_mov_b32 v116, 0
    v_mov_b32 v117, 0
    v_mov_b32 v118, 0
    v_mov_b32 v119, 0
    v_mov_b32 v124, 0
    v_mov_b32 v125, 0
    v_mov_b32 v126, 0
    v_mov_b32 v127, 0
    v_mov_b32 v148, 0
    v_mov_b32 v149, 0
    v_mov_b32 v150, 0
    v_mov_b32 v151, 0
    s_branch L_k2_start
L_post:
L_w3_pad0:
    s_cbranch_execz L_w3_pad2
    v_lshrrev_b32 v2, 6, v0
    v_and_b32 v1, 63, v0
    s_and_b32 s25, s2, 7
    v_readfirstlane_b32 s24, v2
    s_lshr_b32 s26, s2, 3
    v_lshlrev_b32 v4, 4, v1
    s_mov_b32 s37, s57
    s_mov_b32 s16, s8
    s_mov_b32 s17, s9
L_w3_pad1:
    s_cbranch_execz L_w3_pad3
    s_lshl_b32 s27, s25, 2
    s_and_b32 s31, s26, 3
    s_add_u32 s27, s27, s31
    s_lshr_b32 s28, s26, 2
    s_lshl_b32 s29, s25, 1
    s_and_b32 s31, s26, 1
    s_add_u32 s29, s29, s31
    s_lshr_b32 s30, s26, 1
    s_and_b32 s45, s24, 1
    s_mov_b32 s18, 0x1600000
    s_mov_b32 s19, 0x00020000
    s_mov_b32 s15, 0x00020000
    s_mov_b32 s46, 0
    s_cmp_lt_u32 s24, 4
    s_cbranch_scc1 L_p_compute
    s_cmp_lt_u32 s24, 6
    s_cbranch_scc1 L_p_awave
    s_lshl_b32 s36, s28, 16
    s_lshl_b32 s35, s45, 12
    s_add_u32 s36, s36, s35
    s_add_u32 s36, s36, 0x1500000
    s_add_u32 s35, s35, 65536
    s_mov_b32 s33, 0
    v_min_u32 v5, 368, v4
    s_mul_i32 s31, s30, 384
    s_mul_i32 s32, s45, 8192
    s_add_u32 s31, s31, s32
    s_add_u32 s31, s31, 0xfc0000
    s_add_u32 s32, s31, 16384
    buffer_load_dwordx4 v[8:11], v5, s[16:19], s31 offen sc1
    buffer_load_dwordx4 v[12:15], v5, s[16:19], s32 offen sc1
    s_lshl_b32 s32, s45, 10
    s_add_u32 s32, s32, 131072
    v_add_u32 v5, s32, v5
L_pwA_pre:
    s_mov_b32 m0, s35
    s_nop 0
    buffer_load_dwordx4 v4, s[16:19], s36 offen offset:0 sc1 lds
    buffer_load_dwordx4 v4, s[16:19], s36 offen offset:1024 sc1 lds
    buffer_load_dwordx4 v4, s[16:19], s36 offen offset:2048 sc1 lds
    buffer_load_dwordx4 v4, s[16:19], s36 offen offset:3072 sc1 lds
    s_add_u32 s36, s36, 8192
    s_add_u32 s35, s35, 8192
    s_add_u32 s33, s33, 1
    s_cmp_ge_u32 s35, 131072
    s_cselect_b32 s31, 65536, 0
    s_sub_u32 s35, s35, s31
    s_cmp_lt_u32 s33, 7
    s_cbranch_scc1 L_pwA_pre
L_pwA_ld:
    s_waitcnt vmcnt(24)
    s_barrier
    s_mov_b32 m0, s35
    s_nop 0
    buffer_load_dwordx4 v4, s[16:19], s36 offen offset:0 sc1 lds
    buffer_load_dwordx4 v4, s[16:19], s36 offen offset:1024 sc1 lds
    buffer_load_dwordx4 v4, s[16:19], s36 offen offset:2048 sc1 lds
    buffer_load_dwordx4 v4, s[16:19], s36 offen offset:3072 sc1 lds
    s_add_u32 s36, s36, 8192
    s_add_u32 s35, s35, 8192
    s_add_u32 s33, s33, 1
    s_cmp_ge_u32 s35, 131072
    s_cselect_b32 s31, 65536, 0
    s_sub_u32 s35, s35, s31
    s_cmp_lt_u32 s33, 8
    s_cbranch_scc1 L_pwA_ld
    s_min_u32 s36, s30, 14
    s_mul_i32 s36, s36, 196608
    s_mul_i32 s35, s45, 6144
    s_add_u32 s36, s36, s35
    s_add_u32 s36, s36, 0x1000000
    s_add_u32 s35, s35, 135168
    s_mov_b32 s33, 0
    s_waitcnt vmcnt(24)
    s_barrier
    v_add_f32 v8, v8, v12
    v_add_f32 v9, v9, v13
    v_add_f32 v10, v10, v14
    v_add_f32 v11, v11, v15
    ds_write_b128 v5, v[8:11]
    s_waitcnt lgkmcnt(0)
    s_waitcnt vmcnt(20)
    s_barrier
    s_waitcnt vmcnt(16)
    s_barrier
    s_waitcnt vmcnt(12)
    s_barrier
    s_waitcnt vmcnt(8)
    s_barrier
L_pwB_e:
    s_mov_b32 m0, s35
    s_add_u32 s32, s36, 3072
    buffer_load_dwordx4 v4, s[16:19], s36 offen sc1 lds
    buffer_load_dwordx4 v4, s[16:19], s36 offen offset:1024 sc1 lds
L_w3_pad2:
    s_cbranch_execz L_w3_pad4
    buffer_load_dwordx4 v4, s[16:19], s36 offen offset:2048 sc1 lds
    s_add_u32 m0, m0, 3072
    s_add_u32 s36, s36, 12288
    buffer_load_dwordx4 v4, s[16:19], s32 offen sc1 lds
    buffer_load_dwordx4 v4, s[16:19], s32 offen offset:1024 sc1 lds
    buffer_load_dwordx4 v4, s[16:19], s32 offen offset:2048 sc1 lds
    s_add_u32 s35, s35, 12288
    s_add_u32 s33, s33, 1
    s_cmp_ge_u32 s35, 159744
    s_cselect_b32 s31, 110592, 0
    s_sub_u32 s35, s35, s31
    s_cmp_lt_u32 s33, 2
    s_cbranch_scc1 L_pwB_e
    s_waitcnt vmcnt(16)
    s_barrier
    s_waitcnt vmcnt(12)
    s_barrier
    s_barrier
    s_barrier
    s_cmp_eq_u32 s30, 15
    s_cbranch_scc1 L_p_wC
L_pwB_pre:
    s_mov_b32 m0, s35
    s_add_u32 s32, s36, 3072
    buffer_load_dwordx4 v4, s[16:19], s36 offen sc1 lds
    buffer_load_dwordx4 v4, s[16:19], s36 offen offset:1024 sc1 lds
    buffer_load_dwordx4 v4, s[16:19], s36 offen offset:2048 sc1 lds
    s_add_u32 m0, m0, 3072
    s_add_u32 s36, s36, 12288
    buffer_load_dwordx4 v4, s[16:19], s32 offen sc1 lds
    buffer_load_dwordx4 v4, s[16:19], s32 offen offset:1024 sc1 lds
    buffer_load_dwordx4 v4, s[16:19], s32 offen offset:2048 sc1 lds
    s_add_u32 s35, s35, 12288
    s_add_u32 s33, s33, 1
    s_cmp_ge_u32 s35, 159744
    s_cselect_b32 s31, 110592, 0
    s_sub_u32 s35, s35, s31
    s_cmp_lt_u32 s33, 4
    s_cbranch_scc1 L_pwB_pre
L_pwB_ld:
    s_waitcnt vmcnt(18)
    s_barrier
    s_mov_b32 m0, s35
    s_add_u32 s32, s36, 3072
    buffer_load_dwordx4 v4, s[16:19], s36 offen sc1 lds
    buffer_load_dwordx4 v4, s[16:19], s36 offen offset:1024 sc1 lds
    buffer_load_dwordx4 v4, s[16:19], s36 offen offset:2048 sc1 lds
    s_add_u32 m0, m0, 3072
    s_add_u32 s36, s36, 12288
    buffer_load_dwordx4 v4, s[16:19], s32 offen sc1 lds
    buffer_load_dwordx4 v4, s[16:19], s32 offen offset:1024 sc1 lds
    buffer_load_dwordx4 v4, s[16:19], s32 offen offset:2048 sc1 lds
    s_add_u32 s35, s35, 12288
    s_add_u32 s33, s33, 1
    s_cmp_ge_u32 s35, 159744
    s_cselect_b32 s31, 110592, 0
    s_sub_u32 s35, s35, s31
    s_cmp_lt_u32 s33, 16
    s_cbranch_scc1 L_pwB_ld
L_p_wC:
    s_lshl_b32 s35, s45, 12
    s_mul_i32 s36, s28, 180224
    s_add_u32 s36, s36, s35
    s_add_u32 s36, s36, 0x1300000
    s_add_u32 s35, s35, 114688
    s_mov_b32 s33, 0
    s_cmp_eq_u32 s30, 15
    s_cbranch_scc1 L_p_wC0
    s_waitcnt vmcnt(18)
    s_barrier
    s_mov_b32 m0, s35
    s_nop 0
    buffer_load_dwordx4 v4, s[16:19], s36 offen offset:0 sc1 lds
    buffer_load_dwordx4 v4, s[16:19], s36 offen offset:1024 sc1 lds
    buffer_load_dwordx4 v4, s[16:19], s36 offen offset:2048 sc1 lds
    buffer_load_dwordx4 v4, s[16:19], s36 offen offset:3072 sc1 lds
    s_add_u32 s36, s36, 8192
    s_add_u32 s35, s35, 8192
    s_add_u32 s33, s33, 1
    s_cmp_ge_u32 s35, 163840
    s_cselect_b32 s31, 98304, 0
    s_sub_u32 s35, s35, s31
    s_mov_b32 m0, s35
    s_nop 0
    buffer_load_dwordx4 v4, s[16:19], s36 offen offset:0 sc1 lds
L_w3_pad3:
    s_cbranch_execz L_w3_pad5
    buffer_load_dwordx4 v4, s[16:19], s36 offen offset:1024 sc1 lds
    buffer_load_dwordx4 v4, s[16:19], s36 offen offset:2048 sc1 lds
    buffer_load_dwordx4 v4, s[16:19], s36 offen offset:3072 sc1 lds
    s_add_u32 s36, s36, 8192
    s_add_u32 s35, s35, 8192
    s_add_u32 s33, s33, 1
    s_cmp_ge_u32 s35, 163840
    s_cselect_b32 s31, 98304, 0
    s_sub_u32 s35, s35, s31
    s_waitcnt vmcnt(20)
    s_barrier
    s_mov_b32 m0, s35
    s_nop 0
    buffer_load_dwordx4 v4, s[16:19], s36 offen offset:0 sc1 lds
    buffer_load_dwordx4 v4, s[16:19], s36 offen offset:1024 sc1 lds
    buffer_load_dwordx4 v4, s[16:19], s36 offen offset:2048 sc1 lds
    buffer_load_dwordx4 v4, s[16:19], s36 offen offset:3072 sc1 lds
    s_add_u32 s36, s36, 8192
    s_add_u32 s35, s35, 8192
    s_add_u32 s33, s33, 1
    s_cmp_ge_u32 s35, 163840
    s_cselect_b32 s31, 98304, 0
    s_sub_u32 s35, s35, s31
    s_mov_b32 m0, s35
    s_nop 0
    buffer_load_dwordx4 v4, s[16:19], s36 offen offset:0 sc1 lds
    buffer_load_dwordx4 v4, s[16:19], s36 offen offset:1024 sc1 lds
    buffer_load_dwordx4 v4, s[16:19], s36 offen offset:2048 sc1 lds
    buffer_load_dwordx4 v4, s[16:19], s36 offen offset:3072 sc1 lds
    s_add_u32 s36, s36, 8192
    s_add_u32 s35, s35, 8192
    s_add_u32 s33, s33, 1
    s_cmp_ge_u32 s35, 163840
    s_cselect_b32 s31, 98304, 0
    s_sub_u32 s35, s35, s31
    s_waitcnt vmcnt(22)
    s_barrier
    s_mov_b32 m0, s35
    s_nop 0
    buffer_load_dwordx4 v4, s[16:19], s36 offen offset:0 sc1 lds
    buffer_load_dwordx4 v4, s[16:19], s36 offen offset:1024 sc1 lds
    buffer_load_dwordx4 v4, s[16:19], s36 offen offset:2048 sc1 lds
    buffer_load_dwordx4 v4, s[16:19], s36 offen offset:3072 sc1 lds
    s_add_u32 s36, s36, 8192
    s_add_u32 s35, s35, 8192
    s_add_u32 s33, s33, 1
    s_cmp_ge_u32 s35, 163840
    s_cselect_b32 s31, 98304, 0
    s_sub_u32 s35, s35, s31
    s_mov_b32 m0, s35
    s_nop 0
    buffer_load_dwordx4 v4, s[16:19], s36 offen offset:0 sc1 lds
    buffer_load_dwordx4 v4, s[16:19], s36 offen offset:1024 sc1 lds
    buffer_load_dwordx4 v4, s[16:19], s36 offen offset:2048 sc1 lds
    buffer_load_dwordx4 v4, s[16:19], s36 offen offset:3072 sc1 lds
    s_add_u32 s36, s36, 8192
    s_add_u32 s35, s35, 8192
    s_add_u32 s33, s33, 1
    s_cmp_ge_u32 s35, 163840
    s_cselect_b32 s31, 98304, 0
    s_sub_u32 s35, s35, s31
    s_waitcnt vmcnt(24)
    s_barrier
    s_mov_b32 m0, s35
    s_nop 0
    buffer_load_dwordx4 v4, s[16:19], s36 offen offset:0 sc1 lds
    buffer_load_dwordx4 v4, s[16:19], s36 offen offset:1024 sc1 lds
    buffer_load_dwordx4 v4, s[16:19], s36 offen offset:2048 sc1 lds
    buffer_load_dwordx4 v4, s[16:19], s36 offen offset:3072 sc1 lds
    s_add_u32 s36, s36, 8192
    s_add_u32 s35, s35, 8192
    s_add_u32 s33, s33, 1
    s_cmp_ge_u32 s35, 163840
    s_cselect_b32 s31, 98304, 0
    s_sub_u32 s35, s35, s31
    s_mov_b32 m0, s35
    s_nop 0
    buffer_load_dwordx4 v4, s[16:19], s36 offen offset:0 sc1 lds
L_w3_pad4:
    s_cbranch_execz L_w3_pad6
    buffer_load_dwordx4 v4, s[16:19], s36 offen offset:1024 sc1 lds
    buffer_load_dwordx4 v4, s[16:19], s36 offen offset:2048 sc1 lds
    buffer_load_dwordx4 v4, s[16:19], s36 offen offset:3072 sc1 lds
    s_add_u32 s36, s36, 8192
    s_add_u32 s35, s35, 8192
    s_add_u32 s33, s33, 1
    s_cmp_ge_u32 s35, 163840
    s_cselect_b32 s31, 98304, 0
    s_sub_u32 s35, s35, s31
    s_barrier
    s_branch L_p_wC1
L_p_wC0:
    s_waitcnt vmcnt(0)
L_p_wC1:
    s_cmp_ge_u32 s33, 10
    s_cbranch_scc1 L_pwC_ld
L_pwC_pre:
    s_mov_b32 m0, s35
    s_nop 0
    buffer_load_dwordx4 v4, s[16:19], s36 offen offset:0 sc1 lds
    buffer_load_dwordx4 v4, s[16:19], s36 offen offset:1024 sc1 lds
    buffer_load_dwordx4 v4, s[16:19], s36 offen offset:2048 sc1 lds
    buffer_load_dwordx4 v4, s[16:19], s36 offen offset:3072 sc1 lds
    s_add_u32 s36, s36, 8192
    s_add_u32 s35, s35, 8192
    s_add_u32 s33, s33, 1
    s_cmp_ge_u32 s35, 163840
    s_cselect_b32 s31, 98304, 0
    s_sub_u32 s35, s35, s31
    s_cmp_lt_u32 s33, 10
    s_cbranch_scc1 L_pwC_pre
L_pwC_ld:
    s_waitcnt vmcnt(36)
    s_barrier
    s_mov_b32 m0, s35
    s_nop 0
    buffer_load_dwordx4 v4, s[16:19], s36 offen offset:0 sc1 lds
    buffer_load_dwordx4 v4, s[16:19], s36 offen offset:1024 sc1 lds
    buffer_load_dwordx4 v4, s[16:19], s36 offen offset:2048 sc1 lds
    buffer_load_dwordx4 v4, s[16:19], s36 offen offset:3072 sc1 lds
    s_add_u32 s36, s36, 8192
    s_add_u32 s35, s35, 8192
    s_add_u32 s33, s33, 1
    s_cmp_ge_u32 s35, 163840
    s_cselect_b32 s31, 98304, 0
    s_sub_u32 s35, s35, s31
    s_cmp_lt_u32 s33, 22
    s_cbranch_scc1 L_pwC_ld
    s_waitcnt vmcnt(36)
    s_barrier
    s_waitcnt vmcnt(32)
    s_barrier
    s_waitcnt vmcnt(28)
    s_barrier
    s_waitcnt vmcnt(24)
    s_barrier
    s_waitcnt vmcnt(20)
    s_barrier
    s_lshl_b32 s31, s26, 1
    s_add_u32 s31, s31, s45
    s_cmp_lt_u32 s31, 1
    s_cbranch_scc0 L_p_nowb
    s_waitcnt vmcnt(0)
    buffer_wbl2 sc1
    s_barrier
    s_barrier
    s_barrier
    s_barrier
    s_barrier
    s_endpgm
L_p_nowb:
    s_waitcnt vmcnt(16)
    s_barrier
    s_waitcnt vmcnt(12)
    s_barrier
    s_waitcnt vmcnt(8)
    s_barrier
    s_waitcnt vmcnt(4)
    s_barrier
    s_waitcnt vmcnt(0)
    s_barrier
    s_endpgm
L_p_awave:
    v_lshlrev_b32 v9, 2, v1
    s_lshl_b32 s40, s27, 1
    s_add_u32 s40, s40, s45
    s_lshl_b32 s36, s40, 15
    s_add_u32 s36, s36, 0x600000
    s_lshl_b32 s35, s45, 12
    s_add_u32 s35, s35, 0
    s_mov_b32 s33, 0
    v_add_u32 v8, 30720, v4
    v_lshrrev_b32 v2, 3, v1
    v_and_b32 v3, 7, v1
    v_xor_b32 v3, v3, v2
    v_lshlrev_b32 v2, 10, v2
    v_lshl_add_u32 v2, v3, 4, v2
    s_lshl_b32 s31, s40, 15
    s_lshl_b32 s32, s28, 7
    s_add_u32 s31, s31, s32
    s_add_u32 m0, s35, 57344
    s_mov_b32 s14, 0x200000
    s_mov_b32 s12, s58
    s_mov_b32 s13, s59
L_w3_pad5:
    s_cbranch_execz L_w3_pad7
    buffer_load_dwordx4 v2, s[12:15], s31 offen lds
    s_add_u32 s31, s31, 7168
    buffer_load_dwordx4 v2, s[12:15], s31 offen offset:1024 lds
    s_add_u32 s31, s31, 7168
    buffer_load_dwordx4 v2, s[12:15], s31 offen offset:2048 lds
    s_add_u32 s31, s31, 7168
    buffer_load_dwordx4 v2, s[12:15], s31 offen offset:3072 lds
    s_lshl_b32 s34, s25, 12
    s_and_b32 s31, s40, 7
    s_lshl_b32 s31, s31, 2
    s_add_u32 s34, s34, s31
    s_add_u32 s34, s34, 0xfea000
    v_and_b32 v6, 31, v1
    v_lshlrev_b32 v6, 7, v6
    s_mov_b32 s44, 0
L_p_pollo:
    buffer_load_dword v5, v6, s[16:19], s34 offen sc1
    s_waitcnt vmcnt(0)
L_p_pollo_c:
    s_add_u32 s44, s44, 1
    v_cmp_gt_u32 vcc, 1, v5
    s_cmp_ge_u32 s44, 400000
    s_cbranch_scc1 L_p_pollo_x
    s_cbranch_vccnz L_p_pollo
L_p_pollo_x:
L_paA_pre:
    s_mov_b32 m0, s35
    s_nop 0
    buffer_load_dwordx4 v4, s[16:19], s36 offen offset:0 sc1 lds
    buffer_load_dwordx4 v4, s[16:19], s36 offen offset:1024 sc1 lds
    buffer_load_dwordx4 v4, s[16:19], s36 offen offset:2048 sc1 lds
    buffer_load_dwordx4 v4, s[16:19], s36 offen offset:3072 sc1 lds
    s_add_u32 s36, s36, 4096
    s_add_u32 s35, s35, 8192
    s_add_u32 s33, s33, 1
    s_cmp_ge_u32 s35, 65536
    s_cselect_b32 s31, 65536, 0
    s_sub_u32 s35, s35, s31
    s_cmp_lt_u32 s33, 6
    s_cbranch_scc1 L_paA_pre
L_paA_ld:
    s_waitcnt vmcnt(20)
    s_barrier
    s_mov_b32 m0, s35
    s_nop 0
    buffer_load_dwordx4 v4, s[16:19], s36 offen offset:0 sc1 lds
    buffer_load_dwordx4 v4, s[16:19], s36 offen offset:1024 sc1 lds
    buffer_load_dwordx4 v4, s[16:19], s36 offen offset:2048 sc1 lds
    buffer_load_dwordx4 v4, s[16:19], s36 offen offset:3072 sc1 lds
    s_add_u32 s36, s36, 4096
    s_add_u32 s35, s35, 8192
    s_add_u32 s33, s33, 1
    s_cmp_ge_u32 s35, 65536
    s_cselect_b32 s31, 65536, 0
    s_sub_u32 s35, s35, s31
    s_cmp_lt_u32 s33, 8
    s_cbranch_scc1 L_paA_ld
    s_waitcnt vmcnt(20)
    s_barrier
    s_waitcnt vmcnt(16)
    s_barrier
    s_waitcnt vmcnt(12)
    s_barrier
    s_waitcnt vmcnt(8)
    s_barrier
    s_waitcnt vmcnt(4)
    s_barrier
    s_waitcnt vmcnt(0)
    s_barrier
    s_barrier
    s_barrier
    s_cmp_eq_u32 s30, 15
    s_cbranch_scc1 L_p_aC
    s_lshl_b32 s31, s29, 2
    s_lshl_b32 s32, s45, 1
    s_add_u32 s31, s31, s32
    s_lshl_b32 s36, s31, 15
    s_add_u32 s36, s36, 0x800000
    s_lshl_b32 s34, s31, 6
    s_add_u32 s34, s34, 0xfe0000
    s_lshl_b32 s35, s45, 12
    s_add_u32 s35, s35, 0
    s_mov_b32 s33, 0
    v_and_b32 v6, 0x7c, v9
    s_mov_b32 s44, 0
L_p_pollaB:
    buffer_load_dword v5, v6, s[16:19], s34 offen sc1
    s_waitcnt vmcnt(0)
L_p_pollaB_c:
    s_add_u32 s44, s44, 1
    v_cmp_gt_u32 vcc, 1, v5
    s_cmp_ge_u32 s44, 400000
    s_cbranch_scc1 L_p_pollaB_x
    s_cbranch_vccnz L_p_pollaB
L_p_pollaB_x:
    s_lshl_b32 s31, s45, 2
    s_add_u32 s31, s31, 163776
    v_mov_b32 v5, s31
    ds_write_b32 v5, v5
L_paB_pre:
    s_mov_b32 m0, s35
    s_nop 0
    buffer_load_dwordx4 v4, s[16:19], s36 offen sc1 lds
L_w3_pad6:
    s_cbranch_execz L_w3_pad8
    buffer_load_dwordx4 v4, s[16:19], s36 offen offset:1024 sc1 lds
    buffer_load_dwordx4 v8, s[16:19], s36 offen offset:2048 sc1 lds
    buffer_load_dwordx4 v8, s[16:19], s36 offen offset:3072 sc1 lds
    s_add_u32 s36, s36, 2048
    s_add_u32 s35, s35, 8192
    s_add_u32 s33, s33, 1
    s_cmp_ge_u32 s35, 49152
    s_cselect_b32 s31, 49152, 0
    s_sub_u32 s35, s35, s31
    s_cmp_lt_u32 s33, 3
    s_cbranch_scc1 L_paB_pre
L_paB_ld:
    s_waitcnt vmcnt(8)
    s_barrier
    s_mov_b32 m0, s35
    s_nop 0
    buffer_load_dwordx4 v4, s[16:19], s36 offen sc1 lds
    buffer_load_dwordx4 v4, s[16:19], s36 offen offset:1024 sc1 lds
    buffer_load_dwordx4 v8, s[16:19], s36 offen offset:2048 sc1 lds
    buffer_load_dwordx4 v8, s[16:19], s36 offen offset:3072 sc1 lds
    s_add_u32 s36, s36, 2048
    s_add_u32 s35, s35, 8192
    s_add_u32 s33, s33, 1
    s_cmp_ge_u32 s35, 49152
    s_cselect_b32 s31, 49152, 0
    s_sub_u32 s35, s35, s31
    s_cmp_lt_u32 s33, 16
    s_cbranch_scc1 L_paB_ld
    s_waitcnt vmcnt(8)
    s_barrier
    s_waitcnt vmcnt(4)
    s_barrier
    s_waitcnt vmcnt(0)
    s_barrier
    s_barrier
L_p_aC:
    s_mul_i32 s38, s40, 88064
    s_add_u32 s38, s38, 0xa00000
    s_add_u32 s36, s38, 86016
    s_lshl_b32 s34, s40, 6
    s_add_u32 s34, s34, 0xfe1000
    s_lshl_b32 s35, s45, 12
    s_add_u32 s35, s35, 0
    s_mov_b32 s33, 0
    v_add_u32 v8, 4096, v4
    s_add_u32 s39, s38, 86016
    v_min_u32 v6, 56, v9
    s_mov_b32 s44, 0
L_p_pollaC:
    buffer_load_dword v5, v6, s[16:19], s34 offen sc1
    s_waitcnt vmcnt(0)
L_p_pollaC_c:
    s_add_u32 s44, s44, 1
    v_cmp_gt_u32 vcc, 1, v5
    s_cmp_ge_u32 s44, 400000
    s_cbranch_scc1 L_p_pollaC_x
    s_cbranch_vccnz L_p_pollaC
L_p_pollaC_x:
    s_mov_b32 m0, s35
    s_nop 0
    buffer_load_dwordx4 v4, s[16:19], s36 offen offset:0 sc1 lds
    buffer_load_dwordx4 v4, s[16:19], s36 offen offset:1024 sc1 lds
    s_add_u32 s36, s36, 4096
    s_add_u32 s35, s35, 8192
    s_add_u32 s33, s33, 1
    s_cmp_ge_u32 s35, 65536
    s_cselect_b32 s31, 65536, 0
    s_sub_u32 s35, s35, s31
    s_mov_b32 s36, s38
L_paC_pre:
    s_mov_b32 m0, s35
    s_nop 0
    buffer_load_dwordx4 v4, s[16:19], s36 offen sc1 lds
    buffer_load_dwordx4 v4, s[16:19], s36 offen offset:1024 sc1 lds
    buffer_load_dwordx4 v8, s[16:19], s36 offen offset:2048 sc1 lds
    buffer_load_dwordx4 v8, s[16:19], s36 offen offset:3072 sc1 lds
    s_add_u32 s36, s36, 12288
    s_cmp_ge_u32 s36, s39
    s_cselect_b32 s31, 83968, 0
    s_sub_u32 s36, s36, s31
    s_add_u32 s35, s35, 8192
    s_add_u32 s33, s33, 1
    s_cmp_ge_u32 s35, 65536
    s_cselect_b32 s31, 65536, 0
    s_sub_u32 s35, s35, s31
    s_cmp_lt_u32 s33, 4
    s_cbranch_scc1 L_paC_pre
    s_mov_b32 s43, 2
L_paC_l1:
    s_waitcnt vmcnt(12)
    s_barrier
    s_mov_b32 m0, s35
    s_nop 0
    buffer_load_dwordx4 v4, s[16:19], s36 offen sc1 lds
L_w3_pad7:
    s_cbranch_execz L_w3_pad9
    buffer_load_dwordx4 v4, s[16:19], s36 offen offset:1024 sc1 lds
    buffer_load_dwordx4 v8, s[16:19], s36 offen offset:2048 sc1 lds
    buffer_load_dwordx4 v8, s[16:19], s36 offen offset:3072 sc1 lds
    s_add_u32 s36, s36, 12288
    s_cmp_ge_u32 s36, s39
    s_cselect_b32 s31, 83968, 0
    s_sub_u32 s36, s36, s31
    s_add_u32 s35, s35, 8192
    s_add_u32 s33, s33, 1
    s_cmp_ge_u32 s35, 65536
    s_cselect_b32 s31, 65536, 0
    s_sub_u32 s35, s35, s31
    s_mov_b32 s31, 8256
    s_bitcmp1_b32 s31, s33
    s_cbranch_scc0 L_paC_ns
    buffer_load_dword v5, v6, s[16:19], s34 offen sc1
L_paC_ns:
    s_mov_b32 s31, 33024
    s_bitcmp1_b32 s31, s33
    s_cbranch_scc0 L_paC_l1
    s_mov_b32 s44, 0
    s_waitcnt vmcnt(8)
    s_branch L_p_pollaC2_c
L_p_pollaC2:
    buffer_load_dword v5, v6, s[16:19], s34 offen sc1
    s_waitcnt vmcnt(0)
L_p_pollaC2_c:
    s_add_u32 s44, s44, 1
    v_cmp_gt_u32 vcc, s43, v5
    s_cmp_ge_u32 s44, 400000
    s_cbranch_scc1 L_p_pollaC2_x
    s_cbranch_vccnz L_p_pollaC2
L_p_pollaC2_x:
    s_mov_b32 s43, 3
    s_cmp_lt_u32 s33, 15
    s_cbranch_scc1 L_paC_l1
    s_mov_b32 m0, s35
    s_nop 0
    buffer_load_dwordx4 v4, s[16:19], s36 offen sc1 lds
    buffer_load_dwordx4 v4, s[16:19], s36 offen offset:1024 sc1 lds
    buffer_load_dwordx4 v8, s[16:19], s36 offen offset:2048 sc1 lds
    buffer_load_dwordx4 v8, s[16:19], s36 offen offset:3072 sc1 lds
    s_add_u32 s36, s36, 12288
    s_cmp_ge_u32 s36, s39
    s_cselect_b32 s31, 83968, 0
    s_sub_u32 s36, s36, s31
    s_add_u32 s35, s35, 8192
    s_add_u32 s33, s33, 1
    s_cmp_ge_u32 s35, 65536
    s_cselect_b32 s31, 65536, 0
    s_sub_u32 s35, s35, s31
    s_waitcnt vmcnt(16)
    s_barrier
    s_mov_b32 m0, s35
    s_nop 0
    buffer_load_dwordx4 v4, s[16:19], s36 offen sc1 lds
    buffer_load_dwordx4 v4, s[16:19], s36 offen offset:1024 sc1 lds
    buffer_load_dwordx4 v8, s[16:19], s36 offen offset:2048 sc1 lds
    buffer_load_dwordx4 v8, s[16:19], s36 offen offset:3072 sc1 lds
    s_add_u32 s36, s36, 12288
    s_cmp_ge_u32 s36, s39
    s_cselect_b32 s31, 83968, 0
    s_sub_u32 s36, s36, s31
    s_add_u32 s35, s35, 8192
    s_add_u32 s33, s33, 1
    s_cmp_ge_u32 s35, 65536
    s_cselect_b32 s31, 65536, 0
    s_sub_u32 s35, s35, s31
    s_branch L_paC_l3
L_paC_l2:
    s_waitcnt vmcnt(20)
    s_barrier
L_paC_l3:
    s_mov_b32 m0, s35
    s_nop 0
    buffer_load_dwordx4 v4, s[16:19], s36 offen sc1 lds
    buffer_load_dwordx4 v4, s[16:19], s36 offen offset:1024 sc1 lds
    buffer_load_dwordx4 v8, s[16:19], s36 offen offset:2048 sc1 lds
    buffer_load_dwordx4 v8, s[16:19], s36 offen offset:3072 sc1 lds
    s_add_u32 s36, s36, 12288
    s_cmp_ge_u32 s36, s39
    s_cselect_b32 s31, 83968, 0
    s_sub_u32 s36, s36, s31
    s_add_u32 s35, s35, 8192
    s_add_u32 s33, s33, 1
    s_cmp_ge_u32 s35, 65536
    s_cselect_b32 s31, 65536, 0
    s_sub_u32 s35, s35, s31
    s_cmp_lt_u32 s33, 22
    s_cbranch_scc1 L_paC_l2
    s_waitcnt vmcnt(20)
    s_barrier
    s_waitcnt vmcnt(16)
L_w3_pad8:
    s_cbranch_execz L_w3_pad10
    s_barrier
    s_waitcnt vmcnt(12)
    s_barrier
    s_waitcnt vmcnt(8)
    s_barrier
    s_waitcnt vmcnt(4)
    s_barrier
    s_waitcnt vmcnt(0)
    s_barrier
    s_endpgm
L_p_compute:
    s_lshr_b32 s32, s24, 1
    s_lshl_b32 s40, s27, 16
    s_lshl_b32 s34, s45, 15
    s_add_u32 s40, s40, s34
    s_lshl_b32 s34, s28, 7
    s_add_u32 s33, s40, s34
    s_lshl_b32 s34, s32, 6
    s_lshl_b32 s34, s28, 12
    s_add_u32 s40, s40, s34
    s_lshl_b32 s34, s32, 11
    s_add_u32 s40, s40, s34
    s_add_u32 s40, s40, 0x800000
    s_mov_b32 s22, 0x200000
    s_mov_b32 s23, 0x00020000
    s_mov_b32 s20, s60
    s_mov_b32 s21, s61
    v_and_b32 v2, 31, v1
    v_lshrrev_b32 v3, 5, v1
    s_lshl_b32 s34, s32, 2
    v_add_u32 v3, s34, v3
    v_xor_b32 v3, v3, v2
    v_and_b32 v3, 7, v3
    v_lshlrev_b32 v2, 7, v2
    v_lshl_add_u32 v2, v3, 4, v2
    s_lshl_b32 s34, s45, 12
    s_add_u32 s34, s34, 57344
    v_add_u32 v157, s34, v2
    v_xor_b32 v158, 32, v157
    v_and_b32 v9, 32, v1
    v_add_u32 v9, 131072, v9
    s_lshl_b32 s34, s45, 12
    s_add_u32 s34, s34, 0
    v_add_u32 v5, s34, v4
    s_lshl_b32 s34, s32, 10
    s_add_u32 s34, s34, 65536
    v_add_u32 v6, s34, v4
    s_mov_b32 s41, 0
    s_mov_b32 s34, 3
L_p_gemm:
    v_mov_b32 v140, 0
    v_mov_b32 v141, 0
    v_mov_b32 v142, 0
    v_mov_b32 v143, 0
    v_mov_b32 v144, 0
    v_mov_b32 v145, 0
    v_mov_b32 v146, 0
    v_mov_b32 v147, 0
    v_mov_b32 v148, 0
    v_mov_b32 v149, 0
    v_mov_b32 v150, 0
    v_mov_b32 v151, 0
    v_mov_b32 v152, 0
    v_mov_b32 v153, 0
    v_mov_b32 v154, 0
    v_mov_b32 v155, 0
    s_mul_i32 s39, s41, 49152
    v_mov_b32 v8, v5
    v_add_u32 v7, s39, v6
    s_mov_b32 s33, 0
    s_waitcnt lgkmcnt(0)
    s_barrier
    ds_read_b128 v[108:111], v8 offset:0
    ds_read_b128 v[112:115], v7 offset:0
    ds_read_b128 v[116:119], v8 offset:1024
    ds_read_b128 v[120:123], v7 offset:2048
    ds_read_b128 v[124:127], v8 offset:2048
    ds_read_b128 v[128:131], v7 offset:4096
    ds_read_b128 v[132:135], v8 offset:3072
    ds_read_b128 v[136:139], v7 offset:6144
    s_add_u32 s39, s39, 16384
    s_cmp_ge_u32 s39, 98304
    s_cselect_b32 s39, 0, s39
    s_cmp_eq_u32 s41, 0
    s_cbranch_scc0 L_p_g0
    ds_read_b128 v[160:163], v157
    ds_read_b128 v[164:167], v158
    s_waitcnt lgkmcnt(0)
L_p_g0:
    s_barrier
    s_waitcnt lgkmcnt(4)
    v_mfma_f32_32x32x16_bf16 v[140:155], v[112:115], v[108:111], v[140:155]
    ds_read_b128 v[108:111], v8 offset:8192
    ds_read_b128 v[112:115], v7 offset:8192
    v_mfma_f32_32x32x16_bf16 v[140:155], v[120:123], v[116:119], v[140:155]
    ds_read_b128 v[116:119], v8 offset:9216
    ds_read_b128 v[120:123], v7 offset:10240
    s_waitcnt lgkmcnt(4)
    s_cbranch_scc0 L_p_g2
    v_mfma_f32_32x32x16_bf16 v[140:155], v[128:131], v[124:127], v[140:155]
    v_mfma_f32_32x32x16_bf16 v[140:155], v[136:139], v[132:135], v[140:155]
    s_branch L_p_g1
L_p_g2:
L_w3_pad9:
    s_cbranch_execz L_w3_pad11
    s_cmp_ge_u32 s30, 14
    s_cbranch_scc1 L_p_nosig3
    s_cmp_eq_u32 s37, 1
    s_cbranch_scc0 L_p_sigB3_s
    s_waitcnt vmcnt(0)
    s_mov_b64 exec, 1
    buffer_store_dword v9, v2, s[16:19], s35 offen
    s_branch L_p_sigB3_d
L_p_sigB3_s:
    s_waitcnt vmcnt(0)
    s_mov_b64 exec, 1
    buffer_store_dword v9, v2, s[16:19], s35 offen sc0 sc1
L_p_sigB3_d:
    s_mov_b64 exec, -1
L_p_nosig3:
L_p_g1:
    ds_read_b128 v[124:127], v8 offset:10240
    ds_read_b128 v[128:131], v7 offset:12288
    ds_read_b128 v[132:135], v8 offset:11264
    ds_read_b128 v[136:139], v7 offset:14336
    v_add_u32 v8, 0x4000, v8
    v_add_u32 v7, s39, v6
    v_and_b32 v8, 0xffff, v8
L_p_gloop:
    s_barrier
    s_waitcnt lgkmcnt(4)
    v_mfma_f32_32x32x16_bf16 v[140:155], v[112:115], v[108:111], v[140:155]
    ds_read_b128 v[108:111], v8 offset:0
    ds_read_b128 v[112:115], v7 offset:0
    v_mfma_f32_32x32x16_bf16 v[140:155], v[120:123], v[116:119], v[140:155]
    ds_read_b128 v[116:119], v8 offset:1024
    ds_read_b128 v[120:123], v7 offset:2048
    s_add_u32 s39, s39, 16384
    s_cmp_ge_u32 s39, 98304
    s_cselect_b32 s39, 0, s39
    s_waitcnt lgkmcnt(4)
    v_mfma_f32_32x32x16_bf16 v[140:155], v[128:131], v[124:127], v[140:155]
    ds_read_b128 v[124:127], v8 offset:2048
    ds_read_b128 v[128:131], v7 offset:4096
    v_mfma_f32_32x32x16_bf16 v[140:155], v[136:139], v[132:135], v[140:155]
    ds_read_b128 v[132:135], v8 offset:3072
    ds_read_b128 v[136:139], v7 offset:6144
    s_barrier
    s_waitcnt lgkmcnt(4)
    v_mfma_f32_32x32x16_bf16 v[140:155], v[112:115], v[108:111], v[140:155]
    ds_read_b128 v[108:111], v8 offset:8192
    ds_read_b128 v[112:115], v7 offset:8192
    v_mfma_f32_32x32x16_bf16 v[140:155], v[120:123], v[116:119], v[140:155]
    ds_read_b128 v[116:119], v8 offset:9216
    ds_read_b128 v[120:123], v7 offset:10240
    s_add_u32 s33, s33, 1
    s_cmp_lt_u32 s33, s34
    s_waitcnt lgkmcnt(4)
    v_mfma_f32_32x32x16_bf16 v[140:155], v[128:131], v[124:127], v[140:155]
    ds_read_b128 v[124:127], v8 offset:10240
    ds_read_b128 v[128:131], v7 offset:12288
    v_mfma_f32_32x32x16_bf16 v[140:155], v[136:139], v[132:135], v[140:155]
    ds_read_b128 v[132:135], v8 offset:11264
    ds_read_b128 v[136:139], v7 offset:14336
    v_add_u32 v8, 0x4000, v8
    v_add_u32 v7, s39, v6
    v_and_b32 v8, 0xffff, v8
    s_cbranch_scc1 L_p_gloop
    s_waitcnt lgkmcnt(6)
    v_mfma_f32_32x32x16_bf16 v[140:155], v[112:115], v[108:111], v[140:155]
    s_waitcnt lgkmcnt(4)
    v_mfma_f32_32x32x16_bf16 v[140:155], v[120:123], v[116:119], v[140:155]
    s_waitcnt lgkmcnt(2)
    v_mfma_f32_32x32x16_bf16 v[140:155], v[128:131], v[124:127], v[140:155]
    s_waitcnt lgkmcnt(0)
    v_mfma_f32_32x32x16_bf16 v[140:155], v[136:139], v[132:135], v[140:155]
    s_cmp_eq_u32 s41, 0
    s_cbranch_scc0 L_p_nb
    s_barrier
L_p_nb:
    v_lshlrev_b32 v108, 16, v160
    v_and_b32 v109, 0xffff0000, v160
    v_lshlrev_b32 v110, 16, v161
    v_and_b32 v111, 0xffff0000, v161
    v_lshlrev_b32 v112, 16, v162
    v_and_b32 v113, 0xffff0000, v162
    v_lshlrev_b32 v114, 16, v163
    v_and_b32 v115, 0xffff0000, v163
    v_lshlrev_b32 v116, 16, v164
    v_and_b32 v117, 0xffff0000, v164
    v_lshlrev_b32 v118, 16, v165
    v_and_b32 v119, 0xffff0000, v165
L_w3_pad10:
    s_cbranch_execz L_w3_pad12
    v_lshlrev_b32 v120, 16, v166
    v_and_b32 v121, 0xffff0000, v166
    v_lshlrev_b32 v122, 16, v167
    v_and_b32 v123, 0xffff0000, v167
    v_pk_add_f32 v[140:141], v[140:141], v[108:109]
    v_pk_add_f32 v[142:143], v[142:143], v[110:111]
    v_pk_add_f32 v[144:145], v[144:145], v[112:113]
    v_pk_add_f32 v[146:147], v[146:147], v[114:115]
    v_pk_add_f32 v[148:149], v[148:149], v[116:117]
    v_pk_add_f32 v[150:151], v[150:151], v[118:119]
    v_pk_add_f32 v[152:153], v[152:153], v[120:121]
    v_pk_add_f32 v[154:155], v[154:155], v[122:123]
    v_cvt_pk_bf16_f32 v160, v140, v141
    v_cvt_pk_bf16_f32 v161, v142, v143
    v_cvt_pk_bf16_f32 v162, v144, v145
    v_cvt_pk_bf16_f32 v163, v146, v147
    v_cvt_pk_bf16_f32 v164, v148, v149
    v_cvt_pk_bf16_f32 v165, v150, v151
    v_cvt_pk_bf16_f32 v166, v152, v153
    v_cvt_pk_bf16_f32 v167, v154, v155
    s_cbranch_scc0 L_p_final
    s_mov_b32 s32, 0x3f803f80
    v_mov_b32 v124, 0
    v_mov_b32 v125, 0
    s_cmp_eq_u32 s37, 1
    s_cbranch_scc0 L_p_hs
    buffer_store_dwordx4 v[160:163], v4, s[16:19], s40 offen
    buffer_store_dwordx4 v[164:167], v4, s[16:19], s40 offen offset:1024
    s_branch L_p_hd
L_p_hs:
    buffer_store_dwordx4 v[160:163], v4, s[16:19], s40 offen sc1
    buffer_store_dwordx4 v[164:167], v4, s[16:19], s40 offen offset:1024 sc1
L_p_hd:
    v_dot2_f32_bf16 v124, v160, s32, v124
    v_dot2_f32_bf16 v125, v160, v160, v125
    v_dot2_f32_bf16 v124, v161, s32, v124
    v_dot2_f32_bf16 v125, v161, v161, v125
    v_dot2_f32_bf16 v124, v162, s32, v124
    v_dot2_f32_bf16 v125, v162, v162, v125
    v_dot2_f32_bf16 v124, v163, s32, v124
    v_dot2_f32_bf16 v125, v163, v163, v125
    v_dot2_f32_bf16 v124, v164, s32, v124
    v_dot2_f32_bf16 v125, v164, v164, v125
    v_dot2_f32_bf16 v124, v165, s32, v124
    v_dot2_f32_bf16 v125, v165, v165, v125
    v_dot2_f32_bf16 v124, v166, s32, v124
    v_dot2_f32_bf16 v125, v166, v166, v125
    v_dot2_f32_bf16 v124, v167, s32, v124
    v_dot2_f32_bf16 v125, v167, v167, v125
    s_lshl_b32 s31, s27, 1
    s_add_u32 s31, s31, s45
    s_lshl_b32 s31, s31, 3
    s_add_u32 s31, s31, s28
    s_lshr_b32 s32, s24, 1
    s_lshl_b32 s34, s31, 1
    s_add_u32 s34, s34, s32
    s_lshl_b32 s34, s34, 2
    s_add_u32 s34, s34, 0xfe0000
    s_lshl_b32 s31, s31, 9
    s_lshl_b32 s32, s32, 3
    s_add_u32 s31, s31, s32
    s_add_u32 s31, s31, 0xf80000
    v_and_b32 v3, 0x1ff, v4
    v_mov_b32 v126, v124
    v_mov_b32 v127, v125
    s_nop 0
    v_permlane32_swap_b32 v124, v126
    v_permlane32_swap_b32 v125, v127
    s_nop 0
    v_add_f32 v124, v124, v126
    v_add_f32 v125, v125, v127
    v_mov_b32 v2, 0
    v_mov_b32 v128, 1
    s_cmp_eq_u32 s37, 1
    s_cbranch_scc0 L_p_ss
    buffer_store_dwordx2 v[124:125], v3, s[16:19], s31 offen
    s_branch L_p_sd
L_p_ss:
    buffer_store_dwordx2 v[124:125], v3, s[16:19], s31 offen sc1
L_p_sd:
    ds_read_b128 v[12:15], v9 offset:0
    ds_read_b128 v[16:19], v9 offset:16
    ds_read_b128 v[20:23], v9 offset:64
    ds_read_b128 v[24:27], v9 offset:80
L_w3_pad11:
    s_cbranch_execz L_w3_pad13
    ds_read_b128 v[28:31], v9 offset:128
    ds_read_b128 v[32:35], v9 offset:144
    ds_read_b128 v[36:39], v9 offset:192
    ds_read_b128 v[40:43], v9 offset:208
    ds_read_b128 v[44:47], v9 offset:256
    ds_read_b128 v[48:51], v9 offset:272
    ds_read_b128 v[52:55], v9 offset:320
    ds_read_b128 v[56:59], v9 offset:336
    ds_read_b128 v[60:63], v9 offset:1024
    ds_read_b128 v[64:67], v9 offset:1040
    ds_read_b128 v[68:71], v9 offset:1088
    ds_read_b128 v[72:75], v9 offset:1104
    ds_read_b128 v[76:79], v9 offset:1152
    ds_read_b128 v[80:83], v9 offset:1168
    ds_read_b128 v[84:87], v9 offset:1216
    ds_read_b128 v[88:91], v9 offset:1232
    ds_read_b128 v[92:95], v9 offset:1280
    ds_read_b128 v[96:99], v9 offset:1296
    ds_read_b128 v[100:103], v9 offset:1344
    ds_read_b128 v[104:107], v9 offset:1360
    s_cmp_eq_u32 s37, 1
    s_cbranch_scc0 L_p_sigA_s
    s_waitcnt vmcnt(0)
    s_mov_b64 exec, 1
    buffer_store_dword v128, v2, s[16:19], s34 offen
    s_branch L_p_sigA_d
L_p_sigA_s:
    s_waitcnt vmcnt(0)
    s_mov_b64 exec, 1
    buffer_store_dword v128, v2, s[16:19], s34 offen sc0 sc1
L_p_sigA_d:
    s_mov_b64 exec, -1
    s_waitcnt lgkmcnt(0)
    s_barrier
    s_cmp_eq_u32 s30, 15
    s_cbranch_scc1 L_p_toC
    s_lshl_b32 s31, s29, 2
    s_add_u32 s31, s31, s24
    s_lshl_b32 s34, s31, 6
    s_add_u32 s34, s34, 0xfe0000
    s_lshl_b32 s35, s31, 12
    s_add_u32 s35, s35, 0xf80000
    v_lshrrev_b32 v9, 5, v1
    v_lshl_add_u32 v9, v9, 11, v3
    s_mul_i32 s36, s31, 86
    s_mul_i32 s32, s30, 6
    s_add_u32 s36, s36, s32
    s_lshl_b32 s36, s36, 10
    s_add_u32 s36, s36, 0xa00000
    v_lshlrev_b32 v8, 7, v1
    v_min_u32 v8, 6016, v8
    s_lshl_b32 s32, s24, 11
    s_add_u32 s32, s32, 0
    v_add_u32 v159, s32, v4
    s_lshr_b32 s32, s24, 1
    s_lshl_b32 s32, s32, 2
    s_add_u32 s32, s32, 163776
    v_mov_b32 v11, s32
L_p_lp:
    ds_read_b32 v10, v11
    s_waitcnt lgkmcnt(0)
    v_cmp_eq_u32 vcc, 0, v10
    s_cbranch_vccnz L_p_lp
    buffer_load_dwordx4 v[140:143], v9, s[16:19], s35 offen offset:0 sc1
    buffer_load_dwordx4 v[144:147], v9, s[16:19], s35 offen offset:512 sc1
    buffer_load_dwordx4 v[148:151], v9, s[16:19], s35 offen offset:1024 sc1
    buffer_load_dwordx4 v[152:155], v9, s[16:19], s35 offen offset:1536 sc1
    v_mov_b32 v11, v8
    s_lshl_b32 s35, s31, 6
    s_lshl_b32 s32, s30, 2
    s_add_u32 s35, s35, s32
    s_add_u32 s35, s35, 0xfe1000
    v_mov_b32 v8, v159
    v_add_u32 v7, 49152, v4
    v_add_u32 v10, 110592, v4
    s_mov_b32 s33, 0
    s_waitcnt vmcnt(0)
    v_pk_add_f32 v[140:141], v[140:141], v[148:149]
    v_pk_add_f32 v[142:143], v[142:143], v[150:151]
    v_pk_add_f32 v[144:145], v[144:145], v[152:153]
    v_pk_add_f32 v[146:147], v[146:147], v[154:155]
    v_pk_add_f32 v[140:141], v[140:141], v[144:145]
    v_pk_add_f32 v[142:143], v[142:143], v[146:147]
    s_nop 0
    v_pk_add_f32 v[140:141], v[140:141], v[142:143]
L_w3_pad12:
    s_cbranch_execz L_w3_pad14
    s_nop 0
    v_mov_b32 v142, v140
    v_mov_b32 v143, v141
    s_nop 0
    v_permlane32_swap_b32 v140, v142
    v_permlane32_swap_b32 v141, v143
    s_nop 0
    v_add_f32 v140, v140, v142
    v_add_f32 v141, v141, v143
    v_mul_f32 v144, 0xbb000000, v140
    v_mul_f32 v141, 0x3b000000, v141
    s_barrier
    ds_read_b128 v[132:135], v8 offset:0
    ds_read_b128 v[108:111], v10 offset:24576
    ds_read_b128 v[112:115], v10 offset:25600
    ds_read_b128 v[116:119], v10 offset:26624
    ds_read_b128 v[120:123], v10 offset:27648
    ds_read_b128 v[124:127], v10 offset:28672
    ds_read_b128 v[128:131], v10 offset:29696
    v_pk_mul_f32 v[12:13], v[12:13], v[144:145] op_sel_hi:[1,0]
    v_pk_mul_f32 v[14:15], v[14:15], v[144:145] op_sel_hi:[1,0]
    v_pk_mul_f32 v[16:17], v[16:17], v[144:145] op_sel_hi:[1,0]
    v_pk_mul_f32 v[18:19], v[18:19], v[144:145] op_sel_hi:[1,0]
    v_pk_mul_f32 v[20:21], v[20:21], v[144:145] op_sel_hi:[1,0]
    v_pk_mul_f32 v[22:23], v[22:23], v[144:145] op_sel_hi:[1,0]
    v_pk_mul_f32 v[24:25], v[24:25], v[144:145] op_sel_hi:[1,0]
    v_pk_mul_f32 v[26:27], v[26:27], v[144:145] op_sel_hi:[1,0]
    v_pk_mul_f32 v[28:29], v[28:29], v[144:145] op_sel_hi:[1,0]
    v_pk_mul_f32 v[30:31], v[30:31], v[144:145] op_sel_hi:[1,0]
    v_pk_mul_f32 v[32:33], v[32:33], v[144:145] op_sel_hi:[1,0]
    v_pk_mul_f32 v[34:35], v[34:35], v[144:145] op_sel_hi:[1,0]
    v_pk_mul_f32 v[36:37], v[36:37], v[144:145] op_sel_hi:[1,0]
    v_pk_mul_f32 v[38:39], v[38:39], v[144:145] op_sel_hi:[1,0]
    v_pk_mul_f32 v[40:41], v[40:41], v[144:145] op_sel_hi:[1,0]
    v_pk_mul_f32 v[42:43], v[42:43], v[144:145] op_sel_hi:[1,0]
    v_pk_mul_f32 v[44:45], v[44:45], v[144:145] op_sel_hi:[1,0]
    v_pk_mul_f32 v[46:47], v[46:47], v[144:145] op_sel_hi:[1,0]
    v_pk_mul_f32 v[48:49], v[48:49], v[144:145] op_sel_hi:[1,0]
    v_pk_mul_f32 v[50:51], v[50:51], v[144:145] op_sel_hi:[1,0]
    v_pk_mul_f32 v[52:53], v[52:53], v[144:145] op_sel_hi:[1,0]
    v_pk_mul_f32 v[54:55], v[54:55], v[144:145] op_sel_hi:[1,0]
    v_pk_mul_f32 v[56:57], v[56:57], v[144:145] op_sel_hi:[1,0]
    v_pk_mul_f32 v[58:59], v[58:59], v[144:145] op_sel_hi:[1,0]
    v_pk_mul_f32 v[60:61], v[60:61], v[144:145] op_sel_hi:[1,0]
    v_pk_mul_f32 v[62:63], v[62:63], v[144:145] op_sel_hi:[1,0]
    v_pk_mul_f32 v[64:65], v[64:65], v[144:145] op_sel_hi:[1,0]
    v_pk_mul_f32 v[66:67], v[66:67], v[144:145] op_sel_hi:[1,0]
    v_pk_mul_f32 v[68:69], v[68:69], v[144:145] op_sel_hi:[1,0]
    v_pk_mul_f32 v[70:71], v[70:71], v[144:145] op_sel_hi:[1,0]
    v_pk_mul_f32 v[72:73], v[72:73], v[144:145] op_sel_hi:[1,0]
    v_pk_mul_f32 v[74:75], v[74:75], v[144:145] op_sel_hi:[1,0]
    v_pk_mul_f32 v[76:77], v[76:77], v[144:145] op_sel_hi:[1,0]
    v_pk_mul_f32 v[78:79], v[78:79], v[144:145] op_sel_hi:[1,0]
    v_pk_mul_f32 v[80:81], v[80:81], v[144:145] op_sel_hi:[1,0]
    v_pk_mul_f32 v[82:83], v[82:83], v[144:145] op_sel_hi:[1,0]
    v_pk_mul_f32 v[84:85], v[84:85], v[144:145] op_sel_hi:[1,0]
    v_pk_mul_f32 v[86:87], v[86:87], v[144:145] op_sel_hi:[1,0]
    v_pk_mul_f32 v[88:89], v[88:89], v[144:145] op_sel_hi:[1,0]
    v_pk_mul_f32 v[90:91], v[90:91], v[144:145] op_sel_hi:[1,0]
    v_pk_mul_f32 v[92:93], v[92:93], v[144:145] op_sel_hi:[1,0]
    v_pk_mul_f32 v[94:95], v[94:95], v[144:145] op_sel_hi:[1,0]
    v_pk_mul_f32 v[96:97], v[96:97], v[144:145] op_sel_hi:[1,0]
    v_pk_mul_f32 v[98:99], v[98:99], v[144:145] op_sel_hi:[1,0]
    v_pk_mul_f32 v[100:101], v[100:101], v[144:145] op_sel_hi:[1,0]
    v_pk_mul_f32 v[102:103], v[102:103], v[144:145] op_sel_hi:[1,0]
    v_pk_mul_f32 v[104:105], v[104:105], v[144:145] op_sel_hi:[1,0]
    v_pk_mul_f32 v[106:107], v[106:107], v[144:145] op_sel_hi:[1,0]
    v_fma_f32 v3, -v144, v144, v141
    v_max_f32 v3, 0, v3
L_w3_pad13:
    s_cbranch_execz L_w3_pad15
    v_add_f32 v158, 0x3727c5ac, v3
    v_rsq_f32 v9, v158
    s_nop 0
    v_mul_f32 v3, v9, v9
    v_mul_f32 v157, 0xc0135761, v9
    v_mul_f32 v3, v3, v9
    v_mul_f32 v156, 0xbdd2d3e8, v3
    s_waitcnt lgkmcnt(4)
    v_mfma_f32_32x32x16_bf16 v[12:27], v[108:111], v[132:135], v[12:27]
    ds_read_b128 v[136:139], v8 offset:1024
    ds_read_b128 v[108:111], v10 offset:30720
    v_mfma_f32_32x32x16_bf16 v[28:43], v[112:115], v[132:135], v[28:43]
    ds_read_b128 v[112:115], v10 offset:31744
    s_waitcnt lgkmcnt(5)
    v_mfma_f32_32x32x16_bf16 v[44:59], v[116:119], v[132:135], v[44:59]
    ds_read_b128 v[116:119], v10 offset:32768
    v_mfma_f32_32x32x16_bf16 v[60:75], v[120:123], v[132:135], v[60:75]
    ds_read_b128 v[120:123], v10 offset:33792
    s_waitcnt lgkmcnt(5)
    v_mfma_f32_32x32x16_bf16 v[76:91], v[124:127], v[132:135], v[76:91]
    ds_read_b128 v[124:127], v10 offset:34816
    v_mfma_f32_32x32x16_bf16 v[92:107], v[128:131], v[132:135], v[92:107]
    ds_read_b128 v[128:131], v10 offset:35840
    s_barrier
    s_waitcnt lgkmcnt(4)
    v_mfma_f32_32x32x16_bf16 v[12:27], v[108:111], v[136:139], v[12:27]
    ds_read_b128 v[132:135], v8 offset:8192
    ds_read_b128 v[108:111], v10 offset:36864
    v_mfma_f32_32x32x16_bf16 v[28:43], v[112:115], v[136:139], v[28:43]
    ds_read_b128 v[112:115], v10 offset:37888
    s_waitcnt lgkmcnt(5)
    v_mfma_f32_32x32x16_bf16 v[44:59], v[116:119], v[136:139], v[44:59]
    ds_read_b128 v[116:119], v10 offset:38912
    v_mfma_f32_32x32x16_bf16 v[60:75], v[120:123], v[136:139], v[60:75]
    ds_read_b128 v[120:123], v10 offset:39936
    s_waitcnt lgkmcnt(5)
    v_mfma_f32_32x32x16_bf16 v[76:91], v[124:127], v[136:139], v[76:91]
    ds_read_b128 v[124:127], v10 offset:40960
    v_mfma_f32_32x32x16_bf16 v[92:107], v[128:131], v[136:139], v[92:107]
    ds_read_b128 v[128:131], v10 offset:41984
    s_waitcnt lgkmcnt(4)
    v_mfma_f32_32x32x16_bf16 v[12:27], v[108:111], v[132:135], v[12:27]
    ds_read_b128 v[136:139], v8 offset:9216
    ds_read_b128 v[108:111], v10 offset:43008
    v_mfma_f32_32x32x16_bf16 v[28:43], v[112:115], v[132:135], v[28:43]
    ds_read_b128 v[112:115], v10 offset:44032
    s_waitcnt lgkmcnt(5)
    v_mfma_f32_32x32x16_bf16 v[44:59], v[116:119], v[132:135], v[44:59]
    ds_read_b128 v[116:119], v10 offset:45056
    v_mfma_f32_32x32x16_bf16 v[60:75], v[120:123], v[132:135], v[60:75]
    ds_read_b128 v[120:123], v10 offset:46080
    s_waitcnt lgkmcnt(5)
    v_mfma_f32_32x32x16_bf16 v[76:91], v[124:127], v[132:135], v[76:91]
    ds_read_b128 v[124:127], v10 offset:47104
    v_mfma_f32_32x32x16_bf16 v[92:107], v[128:131], v[132:135], v[92:107]
    ds_read_b128 v[128:131], v10 offset:48128
    s_barrier
    s_waitcnt lgkmcnt(4)
    v_mfma_f32_32x32x16_bf16 v[12:27], v[108:111], v[136:139], v[12:27]
    ds_read_b128 v[132:135], v8 offset:16384
    ds_read_b128 v[108:111], v7 offset:0
    v_mfma_f32_32x32x16_bf16 v[28:43], v[112:115], v[136:139], v[28:43]
    ds_read_b128 v[112:115], v7 offset:1024
    s_waitcnt lgkmcnt(5)
    v_mfma_f32_32x32x16_bf16 v[44:59], v[116:119], v[136:139], v[44:59]
    ds_read_b128 v[116:119], v7 offset:2048
    v_mfma_f32_32x32x16_bf16 v[60:75], v[120:123], v[136:139], v[60:75]
    ds_read_b128 v[120:123], v7 offset:3072
    s_waitcnt lgkmcnt(5)
    v_mfma_f32_32x32x16_bf16 v[76:91], v[124:127], v[136:139], v[76:91]
    ds_read_b128 v[124:127], v7 offset:4096
    v_mfma_f32_32x32x16_bf16 v[92:107], v[128:131], v[136:139], v[92:107]
    ds_read_b128 v[128:131], v7 offset:5120
L_w3_pad14:
    s_cbranch_execz L_w3_pad16
    s_waitcnt lgkmcnt(4)
    v_mfma_f32_32x32x16_bf16 v[12:27], v[108:111], v[132:135], v[12:27]
    ds_read_b128 v[136:139], v8 offset:17408
    ds_read_b128 v[108:111], v7 offset:6144
    v_mfma_f32_32x32x16_bf16 v[28:43], v[112:115], v[132:135], v[28:43]
    ds_read_b128 v[112:115], v7 offset:7168
    s_waitcnt lgkmcnt(5)
    v_mfma_f32_32x32x16_bf16 v[44:59], v[116:119], v[132:135], v[44:59]
    ds_read_b128 v[116:119], v7 offset:8192
    v_mfma_f32_32x32x16_bf16 v[60:75], v[120:123], v[132:135], v[60:75]
    ds_read_b128 v[120:123], v7 offset:9216
    s_waitcnt lgkmcnt(5)
    v_mfma_f32_32x32x16_bf16 v[76:91], v[124:127], v[132:135], v[76:91]
    ds_read_b128 v[124:127], v7 offset:10240
    v_mfma_f32_32x32x16_bf16 v[92:107], v[128:131], v[132:135], v[92:107]
    ds_read_b128 v[128:131], v7 offset:11264
    s_barrier
    s_waitcnt lgkmcnt(4)
    v_mfma_f32_32x32x16_bf16 v[12:27], v[108:111], v[136:139], v[12:27]
    ds_read_b128 v[132:135], v8 offset:24576
    ds_read_b128 v[108:111], v7 offset:12288
    v_mfma_f32_32x32x16_bf16 v[28:43], v[112:115], v[136:139], v[28:43]
    ds_read_b128 v[112:115], v7 offset:13312
    s_waitcnt lgkmcnt(5)
    v_mfma_f32_32x32x16_bf16 v[44:59], v[116:119], v[136:139], v[44:59]
    ds_read_b128 v[116:119], v7 offset:14336
    v_mfma_f32_32x32x16_bf16 v[60:75], v[120:123], v[136:139], v[60:75]
    ds_read_b128 v[120:123], v7 offset:15360
    s_waitcnt lgkmcnt(5)
    v_mfma_f32_32x32x16_bf16 v[76:91], v[124:127], v[136:139], v[76:91]
    ds_read_b128 v[124:127], v7 offset:16384
    v_mfma_f32_32x32x16_bf16 v[92:107], v[128:131], v[136:139], v[92:107]
    ds_read_b128 v[128:131], v7 offset:17408
    s_waitcnt lgkmcnt(4)
    v_mfma_f32_32x32x16_bf16 v[12:27], v[108:111], v[132:135], v[12:27]
    ds_read_b128 v[136:139], v8 offset:25600
    ds_read_b128 v[108:111], v7 offset:18432
    v_mfma_f32_32x32x16_bf16 v[28:43], v[112:115], v[132:135], v[28:43]
    ds_read_b128 v[112:115], v7 offset:19456
    s_waitcnt lgkmcnt(5)
    v_mfma_f32_32x32x16_bf16 v[44:59], v[116:119], v[132:135], v[44:59]
    ds_read_b128 v[116:119], v7 offset:20480
    v_mfma_f32_32x32x16_bf16 v[60:75], v[120:123], v[132:135], v[60:75]
    ds_read_b128 v[120:123], v7 offset:21504
    s_waitcnt lgkmcnt(5)
    v_mfma_f32_32x32x16_bf16 v[76:91], v[124:127], v[132:135], v[76:91]
    ds_read_b128 v[124:127], v7 offset:22528
    v_mfma_f32_32x32x16_bf16 v[92:107], v[128:131], v[132:135], v[92:107]
    ds_read_b128 v[128:131], v7 offset:23552
    s_barrier
    s_waitcnt lgkmcnt(4)
    v_mfma_f32_32x32x16_bf16 v[12:27], v[108:111], v[136:139], v[12:27]
    ds_read_b128 v[132:135], v8 offset:32768
    ds_read_b128 v[108:111], v7 offset:24576
    v_mfma_f32_32x32x16_bf16 v[28:43], v[112:115], v[136:139], v[28:43]
    ds_read_b128 v[112:115], v7 offset:25600
    s_waitcnt lgkmcnt(5)
    v_mfma_f32_32x32x16_bf16 v[44:59], v[116:119], v[136:139], v[44:59]
    ds_read_b128 v[116:119], v7 offset:26624
    v_mfma_f32_32x32x16_bf16 v[60:75], v[120:123], v[136:139], v[60:75]
    ds_read_b128 v[120:123], v7 offset:27648
    s_waitcnt lgkmcnt(5)
    v_mfma_f32_32x32x16_bf16 v[76:91], v[124:127], v[136:139], v[76:91]
    ds_read_b128 v[124:127], v7 offset:28672
    v_mfma_f32_32x32x16_bf16 v[92:107], v[128:131], v[136:139], v[92:107]
    ds_read_b128 v[128:131], v7 offset:29696
    s_waitcnt lgkmcnt(4)
    v_mfma_f32_32x32x16_bf16 v[12:27], v[108:111], v[132:135], v[12:27]
    ds_read_b128 v[136:139], v8 offset:33792
    ds_read_b128 v[108:111], v7 offset:30720
    v_mfma_f32_32x32x16_bf16 v[28:43], v[112:115], v[132:135], v[28:43]
L_w3_pad15:
    s_cbranch_execz L_w3_pad17
    ds_read_b128 v[112:115], v7 offset:31744
    s_waitcnt lgkmcnt(5)
    v_mfma_f32_32x32x16_bf16 v[44:59], v[116:119], v[132:135], v[44:59]
    ds_read_b128 v[116:119], v7 offset:32768
    v_mfma_f32_32x32x16_bf16 v[60:75], v[120:123], v[132:135], v[60:75]
    ds_read_b128 v[120:123], v7 offset:33792
    s_waitcnt lgkmcnt(5)
    v_mfma_f32_32x32x16_bf16 v[76:91], v[124:127], v[132:135], v[76:91]
    ds_read_b128 v[124:127], v7 offset:34816
    v_mfma_f32_32x32x16_bf16 v[92:107], v[128:131], v[132:135], v[92:107]
    ds_read_b128 v[128:131], v7 offset:35840
    s_barrier
    s_waitcnt lgkmcnt(4)
    v_mfma_f32_32x32x16_bf16 v[12:27], v[108:111], v[136:139], v[12:27]
    ds_read_b128 v[132:135], v8 offset:40960
    ds_read_b128 v[108:111], v7 offset:36864
    v_mfma_f32_32x32x16_bf16 v[28:43], v[112:115], v[136:139], v[28:43]
    ds_read_b128 v[112:115], v7 offset:37888
    s_waitcnt lgkmcnt(5)
    v_mfma_f32_32x32x16_bf16 v[44:59], v[116:119], v[136:139], v[44:59]
    ds_read_b128 v[116:119], v7 offset:38912
    v_mfma_f32_32x32x16_bf16 v[60:75], v[120:123], v[136:139], v[60:75]
    ds_read_b128 v[120:123], v7 offset:39936
    s_waitcnt lgkmcnt(5)
    v_mfma_f32_32x32x16_bf16 v[76:91], v[124:127], v[136:139], v[76:91]
    ds_read_b128 v[124:127], v7 offset:40960
    v_mfma_f32_32x32x16_bf16 v[92:107], v[128:131], v[136:139], v[92:107]
    ds_read_b128 v[128:131], v7 offset:41984
    s_waitcnt lgkmcnt(4)
    v_mfma_f32_32x32x16_bf16 v[12:27], v[108:111], v[132:135], v[12:27]
    ds_read_b128 v[136:139], v8 offset:41984
    ds_read_b128 v[108:111], v7 offset:43008
    v_mfma_f32_32x32x16_bf16 v[28:43], v[112:115], v[132:135], v[28:43]
    ds_read_b128 v[112:115], v7 offset:44032
    s_waitcnt lgkmcnt(5)
    v_mfma_f32_32x32x16_bf16 v[44:59], v[116:119], v[132:135], v[44:59]
    ds_read_b128 v[116:119], v7 offset:45056
    v_mfma_f32_32x32x16_bf16 v[60:75], v[120:123], v[132:135], v[60:75]
    ds_read_b128 v[120:123], v7 offset:46080
    s_waitcnt lgkmcnt(5)
    v_mfma_f32_32x32x16_bf16 v[76:91], v[124:127], v[132:135], v[76:91]
    ds_read_b128 v[124:127], v7 offset:47104
    v_mfma_f32_32x32x16_bf16 v[92:107], v[128:131], v[132:135], v[92:107]
    ds_read_b128 v[128:131], v7 offset:48128
    s_barrier
    s_waitcnt lgkmcnt(4)
    v_mfma_f32_32x32x16_bf16 v[12:27], v[108:111], v[136:139], v[12:27]
    ds_read_b128 v[132:135], v8 offset:0
    ds_read_b128 v[108:111], v7 offset:49152
    v_mfma_f32_32x32x16_bf16 v[28:43], v[112:115], v[136:139], v[28:43]
    ds_read_b128 v[112:115], v7 offset:50176
    s_waitcnt lgkmcnt(5)
    v_mfma_f32_32x32x16_bf16 v[44:59], v[116:119], v[136:139], v[44:59]
    ds_read_b128 v[116:119], v7 offset:51200
    v_mfma_f32_32x32x16_bf16 v[60:75], v[120:123], v[136:139], v[60:75]
    ds_read_b128 v[120:123], v7 offset:52224
    s_waitcnt lgkmcnt(5)
    v_mfma_f32_32x32x16_bf16 v[76:91], v[124:127], v[136:139], v[76:91]
    ds_read_b128 v[124:127], v7 offset:53248
    v_mfma_f32_32x32x16_bf16 v[92:107], v[128:131], v[136:139], v[92:107]
    ds_read_b128 v[128:131], v7 offset:54272
    s_waitcnt lgkmcnt(4)
    v_mfma_f32_32x32x16_bf16 v[12:27], v[108:111], v[132:135], v[12:27]
    ds_read_b128 v[136:139], v8 offset:1024
    ds_read_b128 v[108:111], v7 offset:55296
    v_mfma_f32_32x32x16_bf16 v[28:43], v[112:115], v[132:135], v[28:43]
    ds_read_b128 v[112:115], v7 offset:56320
    s_waitcnt lgkmcnt(5)
    v_mfma_f32_32x32x16_bf16 v[44:59], v[116:119], v[132:135], v[44:59]
    ds_read_b128 v[116:119], v7 offset:57344
    v_mfma_f32_32x32x16_bf16 v[60:75], v[120:123], v[132:135], v[60:75]
L_w3_pad16:
    s_cbranch_execz L_w3_pad18
    ds_read_b128 v[120:123], v7 offset:58368
    s_waitcnt lgkmcnt(5)
    v_mfma_f32_32x32x16_bf16 v[76:91], v[124:127], v[132:135], v[76:91]
    ds_read_b128 v[124:127], v7 offset:59392
    v_mfma_f32_32x32x16_bf16 v[92:107], v[128:131], v[132:135], v[92:107]
    ds_read_b128 v[128:131], v7 offset:60416
    s_barrier
    s_waitcnt lgkmcnt(4)
    v_mfma_f32_32x32x16_bf16 v[12:27], v[108:111], v[136:139], v[12:27]
    ds_read_b128 v[132:135], v8 offset:8192
    ds_read_b128 v[108:111], v10 offset:0
    v_mfma_f32_32x32x16_bf16 v[28:43], v[112:115], v[136:139], v[28:43]
    ds_read_b128 v[112:115], v10 offset:1024
    s_waitcnt lgkmcnt(5)
    v_mfma_f32_32x32x16_bf16 v[44:59], v[116:119], v[136:139], v[44:59]
    ds_read_b128 v[116:119], v10 offset:2048
    v_mfma_f32_32x32x16_bf16 v[60:75], v[120:123], v[136:139], v[60:75]
    ds_read_b128 v[120:123], v10 offset:3072
    s_waitcnt lgkmcnt(5)
    v_mfma_f32_32x32x16_bf16 v[76:91], v[124:127], v[136:139], v[76:91]
    ds_read_b128 v[124:127], v10 offset:4096
    v_mfma_f32_32x32x16_bf16 v[92:107], v[128:131], v[136:139], v[92:107]
    ds_read_b128 v[128:131], v10 offset:5120
    s_waitcnt lgkmcnt(4)
    v_mfma_f32_32x32x16_bf16 v[12:27], v[108:111], v[132:135], v[12:27]
    ds_read_b128 v[136:139], v8 offset:9216
    ds_read_b128 v[108:111], v10 offset:6144
    v_mfma_f32_32x32x16_bf16 v[28:43], v[112:115], v[132:135], v[28:43]
    ds_read_b128 v[112:115], v10 offset:7168
    s_waitcnt lgkmcnt(5)
    v_mfma_f32_32x32x16_bf16 v[44:59], v[116:119], v[132:135], v[44:59]
    ds_read_b128 v[116:119], v10 offset:8192
    v_mfma_f32_32x32x16_bf16 v[60:75], v[120:123], v[132:135], v[60:75]
    ds_read_b128 v[120:123], v10 offset:9216
    s_waitcnt lgkmcnt(5)
    v_mfma_f32_32x32x16_bf16 v[76:91], v[124:127], v[132:135], v[76:91]
    ds_read_b128 v[124:127], v10 offset:10240
    v_mfma_f32_32x32x16_bf16 v[92:107], v[128:131], v[132:135], v[92:107]
    ds_read_b128 v[128:131], v10 offset:11264
    s_barrier
    s_waitcnt lgkmcnt(4)
    v_mfma_f32_32x32x16_bf16 v[12:27], v[108:111], v[136:139], v[12:27]
    ds_read_b128 v[132:135], v8 offset:16384
    ds_read_b128 v[108:111], v10 offset:12288
    v_mfma_f32_32x32x16_bf16 v[28:43], v[112:115], v[136:139], v[28:43]
    ds_read_b128 v[112:115], v10 offset:13312
    s_waitcnt lgkmcnt(5)
    v_mfma_f32_32x32x16_bf16 v[44:59], v[116:119], v[136:139], v[44:59]
    ds_read_b128 v[116:119], v10 offset:14336
    v_mfma_f32_32x32x16_bf16 v[60:75], v[120:123], v[136:139], v[60:75]
    ds_read_b128 v[120:123], v10 offset:15360
    s_waitcnt lgkmcnt(5)
    v_mfma_f32_32x32x16_bf16 v[76:91], v[124:127], v[136:139], v[76:91]
    ds_read_b128 v[124:127], v10 offset:16384
    v_mfma_f32_32x32x16_bf16 v[92:107], v[128:131], v[136:139], v[92:107]
    ds_read_b128 v[128:131], v10 offset:17408
    s_waitcnt lgkmcnt(4)
    v_mfma_f32_32x32x16_bf16 v[12:27], v[108:111], v[132:135], v[12:27]
    ds_read_b128 v[136:139], v8 offset:17408
    ds_read_b128 v[108:111], v10 offset:18432
    v_mfma_f32_32x32x16_bf16 v[28:43], v[112:115], v[132:135], v[28:43]
    ds_read_b128 v[112:115], v10 offset:19456
    s_waitcnt lgkmcnt(5)
    v_mfma_f32_32x32x16_bf16 v[44:59], v[116:119], v[132:135], v[44:59]
    ds_read_b128 v[116:119], v10 offset:20480
    v_mfma_f32_32x32x16_bf16 v[60:75], v[120:123], v[132:135], v[60:75]
    ds_read_b128 v[120:123], v10 offset:21504
    s_waitcnt lgkmcnt(5)
    v_mfma_f32_32x32x16_bf16 v[76:91], v[124:127], v[132:135], v[76:91]
    ds_read_b128 v[124:127], v10 offset:22528
    v_mfma_f32_32x32x16_bf16 v[92:107], v[128:131], v[132:135], v[92:107]
L_w3_pad17:
    s_cbranch_execz L_w3_pad19
    ds_read_b128 v[128:131], v10 offset:23552
    s_barrier
    s_waitcnt lgkmcnt(4)
    v_mfma_f32_32x32x16_bf16 v[12:27], v[108:111], v[136:139], v[12:27]
    ds_read_b128 v[132:135], v8 offset:24576
    ds_read_b128 v[108:111], v10 offset:24576
    v_mfma_f32_32x32x16_bf16 v[28:43], v[112:115], v[136:139], v[28:43]
    ds_read_b128 v[112:115], v10 offset:25600
    s_waitcnt lgkmcnt(5)
    v_mfma_f32_32x32x16_bf16 v[44:59], v[116:119], v[136:139], v[44:59]
    ds_read_b128 v[116:119], v10 offset:26624
    v_mfma_f32_32x32x16_bf16 v[60:75], v[120:123], v[136:139], v[60:75]
    ds_read_b128 v[120:123], v10 offset:27648
    s_waitcnt lgkmcnt(5)
    v_mfma_f32_32x32x16_bf16 v[76:91], v[124:127], v[136:139], v[76:91]
    ds_read_b128 v[124:127], v10 offset:28672
    v_mfma_f32_32x32x16_bf16 v[92:107], v[128:131], v[136:139], v[92:107]
    ds_read_b128 v[128:131], v10 offset:29696
    s_waitcnt lgkmcnt(4)
    v_mfma_f32_32x32x16_bf16 v[12:27], v[108:111], v[132:135], v[12:27]
    ds_read_b128 v[136:139], v8 offset:25600
    ds_read_b128 v[108:111], v10 offset:30720
    v_mfma_f32_32x32x16_bf16 v[28:43], v[112:115], v[132:135], v[28:43]
    ds_read_b128 v[112:115], v10 offset:31744
    s_waitcnt lgkmcnt(5)
    v_mfma_f32_32x32x16_bf16 v[44:59], v[116:119], v[132:135], v[44:59]
    ds_read_b128 v[116:119], v10 offset:32768
    v_mfma_f32_32x32x16_bf16 v[60:75], v[120:123], v[132:135], v[60:75]
    ds_read_b128 v[120:123], v10 offset:33792
    s_waitcnt lgkmcnt(5)
    v_mfma_f32_32x32x16_bf16 v[76:91], v[124:127], v[132:135], v[76:91]
    ds_read_b128 v[124:127], v10 offset:34816
    v_mfma_f32_32x32x16_bf16 v[92:107], v[128:131], v[132:135], v[92:107]
    ds_read_b128 v[128:131], v10 offset:35840
    s_barrier
    s_waitcnt lgkmcnt(4)
    v_mfma_f32_32x32x16_bf16 v[12:27], v[108:111], v[136:139], v[12:27]
    ds_read_b128 v[132:135], v8 offset:32768
    ds_read_b128 v[108:111], v10 offset:36864
    v_mfma_f32_32x32x16_bf16 v[28:43], v[112:115], v[136:139], v[28:43]
    ds_read_b128 v[112:115], v10 offset:37888
    s_waitcnt lgkmcnt(5)
    v_mfma_f32_32x32x16_bf16 v[44:59], v[116:119], v[136:139], v[44:59]
    ds_read_b128 v[116:119], v10 offset:38912
    v_mfma_f32_32x32x16_bf16 v[60:75], v[120:123], v[136:139], v[60:75]
    ds_read_b128 v[120:123], v10 offset:39936
    s_waitcnt lgkmcnt(5)
    v_mfma_f32_32x32x16_bf16 v[76:91], v[124:127], v[136:139], v[76:91]
    ds_read_b128 v[124:127], v10 offset:40960
    v_mfma_f32_32x32x16_bf16 v[92:107], v[128:131], v[136:139], v[92:107]
    ds_read_b128 v[128:131], v10 offset:41984
    s_waitcnt lgkmcnt(4)
    v_mfma_f32_32x32x16_bf16 v[12:27], v[108:111], v[132:135], v[12:27]
    ds_read_b128 v[136:139], v8 offset:33792
    ds_read_b128 v[108:111], v10 offset:43008
    v_mfma_f32_32x32x16_bf16 v[28:43], v[112:115], v[132:135], v[28:43]
    ds_read_b128 v[112:115], v10 offset:44032
    s_waitcnt lgkmcnt(5)
    v_mfma_f32_32x32x16_bf16 v[44:59], v[116:119], v[132:135], v[44:59]
    ds_read_b128 v[116:119], v10 offset:45056
    v_mfma_f32_32x32x16_bf16 v[60:75], v[120:123], v[132:135], v[60:75]
    ds_read_b128 v[120:123], v10 offset:46080
    s_waitcnt lgkmcnt(5)
    v_mfma_f32_32x32x16_bf16 v[76:91], v[124:127], v[132:135], v[76:91]
    ds_read_b128 v[124:127], v10 offset:47104
    v_mfma_f32_32x32x16_bf16 v[92:107], v[128:131], v[132:135], v[92:107]
    ds_read_b128 v[128:131], v10 offset:48128
    s_barrier
    s_waitcnt lgkmcnt(4)
    v_mfma_f32_32x32x16_bf16 v[12:27], v[108:111], v[136:139], v[12:27]
    ds_read_b128 v[132:135], v8 offset:40960
L_w3_pad18:
    s_cbranch_execz L_w3_pad20
    ds_read_b128 v[108:111], v7 offset:0
    v_mfma_f32_32x32x16_bf16 v[28:43], v[112:115], v[136:139], v[28:43]
    ds_read_b128 v[112:115], v7 offset:1024
    s_waitcnt lgkmcnt(5)
    v_mfma_f32_32x32x16_bf16 v[44:59], v[116:119], v[136:139], v[44:59]
    ds_read_b128 v[116:119], v7 offset:2048
    v_mfma_f32_32x32x16_bf16 v[60:75], v[120:123], v[136:139], v[60:75]
    ds_read_b128 v[120:123], v7 offset:3072
    s_waitcnt lgkmcnt(5)
    v_mfma_f32_32x32x16_bf16 v[76:91], v[124:127], v[136:139], v[76:91]
    ds_read_b128 v[124:127], v7 offset:4096
    v_mfma_f32_32x32x16_bf16 v[92:107], v[128:131], v[136:139], v[92:107]
    ds_read_b128 v[128:131], v7 offset:5120
    s_waitcnt lgkmcnt(4)
    v_mfma_f32_32x32x16_bf16 v[12:27], v[108:111], v[132:135], v[12:27]
    ds_read_b128 v[136:139], v8 offset:41984
    ds_read_b128 v[108:111], v7 offset:6144
    v_mfma_f32_32x32x16_bf16 v[28:43], v[112:115], v[132:135], v[28:43]
    ds_read_b128 v[112:115], v7 offset:7168
    s_waitcnt lgkmcnt(5)
    v_mfma_f32_32x32x16_bf16 v[44:59], v[116:119], v[132:135], v[44:59]
    ds_read_b128 v[116:119], v7 offset:8192
    v_mfma_f32_32x32x16_bf16 v[60:75], v[120:123], v[132:135], v[60:75]
    ds_read_b128 v[120:123], v7 offset:9216
    s_waitcnt lgkmcnt(5)
    v_mfma_f32_32x32x16_bf16 v[76:91], v[124:127], v[132:135], v[76:91]
    ds_read_b128 v[124:127], v7 offset:10240
    v_mfma_f32_32x32x16_bf16 v[92:107], v[128:131], v[132:135], v[92:107]
    ds_read_b128 v[128:131], v7 offset:11264
    s_barrier
    s_waitcnt lgkmcnt(4)
    v_mfma_f32_32x32x16_bf16 v[12:27], v[108:111], v[136:139], v[12:27]
    ds_read_b128 v[132:135], v8 offset:0
    ds_read_b128 v[108:111], v7 offset:12288
    v_mfma_f32_32x32x16_bf16 v[28:43], v[112:115], v[136:139], v[28:43]
    ds_read_b128 v[112:115], v7 offset:13312
    s_waitcnt lgkmcnt(5)
    v_mfma_f32_32x32x16_bf16 v[44:59], v[116:119], v[136:139], v[44:59]
    ds_read_b128 v[116:119], v7 offset:14336
    v_mfma_f32_32x32x16_bf16 v[60:75], v[120:123], v[136:139], v[60:75]
    ds_read_b128 v[120:123], v7 offset:15360
    s_waitcnt lgkmcnt(5)
    v_mfma_f32_32x32x16_bf16 v[76:91], v[124:127], v[136:139], v[76:91]
    ds_read_b128 v[124:127], v7 offset:16384
    v_mfma_f32_32x32x16_bf16 v[92:107], v[128:131], v[136:139], v[92:107]
    ds_read_b128 v[128:131], v7 offset:17408
    s_waitcnt lgkmcnt(4)
    v_mfma_f32_32x32x16_bf16 v[12:27], v[108:111], v[132:135], v[12:27]
    ds_read_b128 v[136:139], v8 offset:1024
    ds_read_b128 v[108:111], v7 offset:18432
    v_mfma_f32_32x32x16_bf16 v[28:43], v[112:115], v[132:135], v[28:43]
    ds_read_b128 v[112:115], v7 offset:19456
    s_waitcnt lgkmcnt(5)
    v_mfma_f32_32x32x16_bf16 v[44:59], v[116:119], v[132:135], v[44:59]
    ds_read_b128 v[116:119], v7 offset:20480
    v_mfma_f32_32x32x16_bf16 v[60:75], v[120:123], v[132:135], v[60:75]
    ds_read_b128 v[120:123], v7 offset:21504
    s_waitcnt lgkmcnt(5)
    v_mfma_f32_32x32x16_bf16 v[76:91], v[124:127], v[132:135], v[76:91]
    ds_read_b128 v[124:127], v7 offset:22528
    v_mfma_f32_32x32x16_bf16 v[92:107], v[128:131], v[132:135], v[92:107]
    ds_read_b128 v[128:131], v7 offset:23552
    s_barrier
    s_waitcnt lgkmcnt(4)
    v_mfma_f32_32x32x16_bf16 v[12:27], v[108:111], v[136:139], v[12:27]
    ds_read_b128 v[132:135], v8 offset:8192
    ds_read_b128 v[108:111], v7 offset:24576
    v_mfma_f32_32x32x16_bf16 v[28:43], v[112:115], v[136:139], v[28:43]
    ds_read_b128 v[112:115], v7 offset:25600
    s_waitcnt lgkmcnt(5)
    v_mfma_f32_32x32x16_bf16 v[44:59], v[116:119], v[136:139], v[44:59]
L_w3_pad19:
    s_cbranch_execz L_w3_pad21
    ds_read_b128 v[116:119], v7 offset:26624
    v_mfma_f32_32x32x16_bf16 v[60:75], v[120:123], v[136:139], v[60:75]
    ds_read_b128 v[120:123], v7 offset:27648
    s_waitcnt lgkmcnt(5)
    v_mfma_f32_32x32x16_bf16 v[76:91], v[124:127], v[136:139], v[76:91]
    ds_read_b128 v[124:127], v7 offset:28672
    v_mfma_f32_32x32x16_bf16 v[92:107], v[128:131], v[136:139], v[92:107]
    ds_read_b128 v[128:131], v7 offset:29696
    s_waitcnt lgkmcnt(4)
    v_mfma_f32_32x32x16_bf16 v[12:27], v[108:111], v[132:135], v[12:27]
    ds_read_b128 v[136:139], v8 offset:9216
    ds_read_b128 v[108:111], v7 offset:30720
    v_mfma_f32_32x32x16_bf16 v[28:43], v[112:115], v[132:135], v[28:43]
    ds_read_b128 v[112:115], v7 offset:31744
    s_waitcnt lgkmcnt(5)
    v_mfma_f32_32x32x16_bf16 v[44:59], v[116:119], v[132:135], v[44:59]
    ds_read_b128 v[116:119], v7 offset:32768
    v_mfma_f32_32x32x16_bf16 v[60:75], v[120:123], v[132:135], v[60:75]
    ds_read_b128 v[120:123], v7 offset:33792
    s_waitcnt lgkmcnt(5)
    v_mfma_f32_32x32x16_bf16 v[76:91], v[124:127], v[132:135], v[76:91]
    ds_read_b128 v[124:127], v7 offset:34816
    v_mfma_f32_32x32x16_bf16 v[92:107], v[128:131], v[132:135], v[92:107]
    ds_read_b128 v[128:131], v7 offset:35840
    s_barrier
    s_waitcnt lgkmcnt(4)
    v_mfma_f32_32x32x16_bf16 v[12:27], v[108:111], v[136:139], v[12:27]
    ds_read_b128 v[132:135], v8 offset:16384
    ds_read_b128 v[108:111], v7 offset:36864
    v_mfma_f32_32x32x16_bf16 v[28:43], v[112:115], v[136:139], v[28:43]
    ds_read_b128 v[112:115], v7 offset:37888
    s_waitcnt lgkmcnt(5)
    v_mfma_f32_32x32x16_bf16 v[44:59], v[116:119], v[136:139], v[44:59]
    ds_read_b128 v[116:119], v7 offset:38912
    v_mfma_f32_32x32x16_bf16 v[60:75], v[120:123], v[136:139], v[60:75]
    ds_read_b128 v[120:123], v7 offset:39936
    s_waitcnt lgkmcnt(5)
    v_mfma_f32_32x32x16_bf16 v[76:91], v[124:127], v[136:139], v[76:91]
    ds_read_b128 v[124:127], v7 offset:40960
    v_mfma_f32_32x32x16_bf16 v[92:107], v[128:131], v[136:139], v[92:107]
    ds_read_b128 v[128:131], v7 offset:41984
    s_waitcnt lgkmcnt(4)
    v_mfma_f32_32x32x16_bf16 v[12:27], v[108:111], v[132:135], v[12:27]
    ds_read_b128 v[136:139], v8 offset:17408
    ds_read_b128 v[108:111], v7 offset:43008
    v_mfma_f32_32x32x16_bf16 v[28:43], v[112:115], v[132:135], v[28:43]
    ds_read_b128 v[112:115], v7 offset:44032
    s_waitcnt lgkmcnt(5)
    v_mfma_f32_32x32x16_bf16 v[44:59], v[116:119], v[132:135], v[44:59]
    ds_read_b128 v[116:119], v7 offset:45056
    v_mfma_f32_32x32x16_bf16 v[60:75], v[120:123], v[132:135], v[60:75]
    ds_read_b128 v[120:123], v7 offset:46080
    s_waitcnt lgkmcnt(5)
    v_mfma_f32_32x32x16_bf16 v[76:91], v[124:127], v[132:135], v[76:91]
    ds_read_b128 v[124:127], v7 offset:47104
    v_mfma_f32_32x32x16_bf16 v[92:107], v[128:131], v[132:135], v[92:107]
    ds_read_b128 v[128:131], v7 offset:48128
    s_barrier
    s_waitcnt lgkmcnt(4)
    v_mfma_f32_32x32x16_bf16 v[12:27], v[108:111], v[136:139], v[12:27]
    ds_read_b128 v[132:135], v8 offset:24576
    ds_read_b128 v[108:111], v7 offset:49152
    v_mfma_f32_32x32x16_bf16 v[28:43], v[112:115], v[136:139], v[28:43]
    ds_read_b128 v[112:115], v7 offset:50176
    s_waitcnt lgkmcnt(5)
    v_mfma_f32_32x32x16_bf16 v[44:59], v[116:119], v[136:139], v[44:59]
    ds_read_b128 v[116:119], v7 offset:51200
    v_mfma_f32_32x32x16_bf16 v[60:75], v[120:123], v[136:139], v[60:75]
    ds_read_b128 v[120:123], v7 offset:52224
    s_waitcnt lgkmcnt(5)
    v_mfma_f32_32x32x16_bf16 v[76:91], v[124:127], v[136:139], v[76:91]
L_w3_pad20:
    s_cbranch_execz L_w3_pad22
    ds_read_b128 v[124:127], v7 offset:53248
    v_mfma_f32_32x32x16_bf16 v[92:107], v[128:131], v[136:139], v[92:107]
    ds_read_b128 v[128:131], v7 offset:54272
    s_waitcnt lgkmcnt(4)
    v_mfma_f32_32x32x16_bf16 v[12:27], v[108:111], v[132:135], v[12:27]
    ds_read_b128 v[136:139], v8 offset:25600
    ds_read_b128 v[108:111], v7 offset:55296
    v_mfma_f32_32x32x16_bf16 v[28:43], v[112:115], v[132:135], v[28:43]
    ds_read_b128 v[112:115], v7 offset:56320
    s_waitcnt lgkmcnt(5)
    v_mfma_f32_32x32x16_bf16 v[44:59], v[116:119], v[132:135], v[44:59]
    ds_read_b128 v[116:119], v7 offset:57344
    v_mfma_f32_32x32x16_bf16 v[60:75], v[120:123], v[132:135], v[60:75]
    ds_read_b128 v[120:123], v7 offset:58368
    s_waitcnt lgkmcnt(5)
    v_mfma_f32_32x32x16_bf16 v[76:91], v[124:127], v[132:135], v[76:91]
    ds_read_b128 v[124:127], v7 offset:59392
    v_mfma_f32_32x32x16_bf16 v[92:107], v[128:131], v[132:135], v[92:107]
    ds_read_b128 v[128:131], v7 offset:60416
    s_waitcnt lgkmcnt(4)
    v_mfma_f32_32x32x16_bf16 v[12:27], v[108:111], v[136:139], v[12:27]
    v_mfma_f32_32x32x16_bf16 v[28:43], v[112:115], v[136:139], v[28:43]
    s_waitcnt lgkmcnt(2)
    v_mfma_f32_32x32x16_bf16 v[44:59], v[116:119], v[136:139], v[44:59]
    v_mfma_f32_32x32x16_bf16 v[60:75], v[120:123], v[136:139], v[60:75]
    s_waitcnt lgkmcnt(0)
    v_mfma_f32_32x32x16_bf16 v[76:91], v[124:127], v[136:139], v[76:91]
    s_barrier
    v_mfma_f32_32x32x16_bf16 v[92:107], v[128:131], v[136:139], v[92:107]
    s_nop 7
    v_pk_mul_f32 v[140:141], v[12:13], v[12:13]
    v_pk_mul_f32 v[142:143], v[14:15], v[14:15]
    v_pk_mul_f32 v[144:145], v[16:17], v[16:17]
    v_pk_mul_f32 v[146:147], v[18:19], v[18:19]
    v_pk_mul_f32 v[148:149], v[20:21], v[20:21]
    v_pk_mul_f32 v[150:151], v[22:23], v[22:23]
    v_pk_mul_f32 v[152:153], v[24:25], v[24:25]
    v_pk_mul_f32 v[154:155], v[26:27], v[26:27]
    v_pk_fma_f32 v[140:141], v[140:141], v[156:157], v[156:157] op_sel:[0,0,1] op_sel_hi:[1,0,1]
    v_pk_fma_f32 v[142:143], v[142:143], v[156:157], v[156:157] op_sel:[0,0,1] op_sel_hi:[1,0,1]
    v_pk_fma_f32 v[144:145], v[144:145], v[156:157], v[156:157] op_sel:[0,0,1] op_sel_hi:[1,0,1]
    v_pk_fma_f32 v[146:147], v[146:147], v[156:157], v[156:157] op_sel:[0,0,1] op_sel_hi:[1,0,1]
    v_pk_fma_f32 v[148:149], v[148:149], v[156:157], v[156:157] op_sel:[0,0,1] op_sel_hi:[1,0,1]
    v_pk_fma_f32 v[150:151], v[150:151], v[156:157], v[156:157] op_sel:[0,0,1] op_sel_hi:[1,0,1]
    v_pk_fma_f32 v[152:153], v[152:153], v[156:157], v[156:157] op_sel:[0,0,1] op_sel_hi:[1,0,1]
    v_pk_fma_f32 v[154:155], v[154:155], v[156:157], v[156:157] op_sel:[0,0,1] op_sel_hi:[1,0,1]
    v_pk_mul_f32 v[140:141], v[140:141], v[12:13]
    v_pk_mul_f32 v[142:143], v[142:143], v[14:15]
    v_pk_mul_f32 v[144:145], v[144:145], v[16:17]
    v_pk_mul_f32 v[146:147], v[146:147], v[18:19]
    v_pk_mul_f32 v[148:149], v[148:149], v[20:21]
    v_pk_mul_f32 v[150:151], v[150:151], v[22:23]
    v_pk_mul_f32 v[152:153], v[152:153], v[24:25]
    v_pk_mul_f32 v[154:155], v[154:155], v[26:27]
    v_exp_f32 v140, v140
    v_exp_f32 v141, v141
    v_exp_f32 v142, v142
    v_exp_f32 v143, v143
    v_exp_f32 v144, v144
    v_exp_f32 v145, v145
    v_exp_f32 v146, v146
    v_exp_f32 v147, v147
    v_exp_f32 v148, v148
    v_exp_f32 v149, v149
    v_exp_f32 v150, v150
    v_exp_f32 v151, v151
    v_exp_f32 v152, v152
    v_exp_f32 v153, v153
    v_exp_f32 v154, v154
    v_exp_f32 v155, v155
    v_pk_mul_f32 v[12:13], v[12:13], v[60:61]
    v_pk_mul_f32 v[14:15], v[14:15], v[62:63]
    v_pk_mul_f32 v[16:17], v[16:17], v[64:65]
    v_pk_mul_f32 v[18:19], v[18:19], v[66:67]
    v_pk_mul_f32 v[20:21], v[20:21], v[68:69]
    v_pk_mul_f32 v[22:23], v[22:23], v[70:71]
L_w3_pad21:
    s_cbranch_execz L_w3_pad23
    v_pk_mul_f32 v[24:25], v[24:25], v[72:73]
    v_pk_mul_f32 v[26:27], v[26:27], v[74:75]
    v_pk_fma_f32 v[140:141], v[140:141], v[158:159], v[158:159] op_sel_hi:[1,0,0]
    v_pk_fma_f32 v[142:143], v[142:143], v[158:159], v[158:159] op_sel_hi:[1,0,0]
    v_pk_fma_f32 v[144:145], v[144:145], v[158:159], v[158:159] op_sel_hi:[1,0,0]
    v_pk_fma_f32 v[146:147], v[146:147], v[158:159], v[158:159] op_sel_hi:[1,0,0]
    v_pk_fma_f32 v[148:149], v[148:149], v[158:159], v[158:159] op_sel_hi:[1,0,0]
    v_pk_fma_f32 v[150:151], v[150:151], v[158:159], v[158:159] op_sel_hi:[1,0,0]
    v_pk_fma_f32 v[152:153], v[152:153], v[158:159], v[158:159] op_sel_hi:[1,0,0]
    v_pk_fma_f32 v[154:155], v[154:155], v[158:159], v[158:159] op_sel_hi:[1,0,0]
    v_rcp_f32 v140, v140
    v_rcp_f32 v141, v141
    v_rcp_f32 v142, v142
    v_rcp_f32 v143, v143
    v_rcp_f32 v144, v144
    v_rcp_f32 v145, v145
    v_rcp_f32 v146, v146
    v_rcp_f32 v147, v147
    v_rcp_f32 v148, v148
    v_rcp_f32 v149, v149
    v_rcp_f32 v150, v150
    v_rcp_f32 v151, v151
    v_rcp_f32 v152, v152
    v_rcp_f32 v153, v153
    v_rcp_f32 v154, v154
    v_rcp_f32 v155, v155
    s_cmp_eq_u32 s37, 1
    v_pk_mul_f32 v[12:13], v[12:13], v[140:141]
    v_pk_mul_f32 v[14:15], v[14:15], v[142:143]
    v_pk_mul_f32 v[16:17], v[16:17], v[144:145]
    v_pk_mul_f32 v[18:19], v[18:19], v[146:147]
    v_pk_mul_f32 v[20:21], v[20:21], v[148:149]
    v_pk_mul_f32 v[22:23], v[22:23], v[150:151]
    v_pk_mul_f32 v[24:25], v[24:25], v[152:153]
    v_pk_mul_f32 v[26:27], v[26:27], v[154:155]
    v_cvt_pk_bf16_f32 v108, v12, v13
    v_cvt_pk_bf16_f32 v109, v14, v15
    v_cvt_pk_bf16_f32 v110, v16, v17
    v_cvt_pk_bf16_f32 v111, v18, v19
    v_cvt_pk_bf16_f32 v112, v20, v21
    v_cvt_pk_bf16_f32 v113, v22, v23
    v_cvt_pk_bf16_f32 v114, v24, v25
    v_cvt_pk_bf16_f32 v115, v26, v27
    s_cbranch_scc0 L_p_gs0
    buffer_store_dwordx4 v[108:111], v4, s[16:19], s36 offen
    buffer_store_dwordx4 v[112:115], v4, s[16:19], s36 offen offset:1024
    s_branch L_p_gd0
L_p_gs0:
    buffer_store_dwordx4 v[108:111], v4, s[16:19], s36 offen sc1
    buffer_store_dwordx4 v[112:115], v4, s[16:19], s36 offen offset:1024 sc1
L_p_gd0:
    s_cmp_eq_u32 s30, 14
    s_cbranch_scc1 L_p_b14
    s_add_u32 s36, s36, 2048
    v_pk_mul_f32 v[140:141], v[28:29], v[28:29]
    v_pk_mul_f32 v[142:143], v[30:31], v[30:31]
    v_pk_mul_f32 v[144:145], v[32:33], v[32:33]
    v_pk_mul_f32 v[146:147], v[34:35], v[34:35]
    v_pk_mul_f32 v[148:149], v[36:37], v[36:37]
    v_pk_mul_f32 v[150:151], v[38:39], v[38:39]
    v_pk_mul_f32 v[152:153], v[40:41], v[40:41]
    v_pk_mul_f32 v[154:155], v[42:43], v[42:43]
    v_pk_fma_f32 v[140:141], v[140:141], v[156:157], v[156:157] op_sel:[0,0,1] op_sel_hi:[1,0,1]
    v_pk_fma_f32 v[142:143], v[142:143], v[156:157], v[156:157] op_sel:[0,0,1] op_sel_hi:[1,0,1]
    v_pk_fma_f32 v[144:145], v[144:145], v[156:157], v[156:157] op_sel:[0,0,1] op_sel_hi:[1,0,1]
    v_pk_fma_f32 v[146:147], v[146:147], v[156:157], v[156:157] op_sel:[0,0,1] op_sel_hi:[1,0,1]
    v_pk_fma_f32 v[148:149], v[148:149], v[156:157], v[156:157] op_sel:[0,0,1] op_sel_hi:[1,0,1]
    v_pk_fma_f32 v[150:151], v[150:151], v[156:157], v[156:157] op_sel:[0,0,1] op_sel_hi:[1,0,1]
    v_pk_fma_f32 v[152:153], v[152:153], v[156:157], v[156:157] op_sel:[0,0,1] op_sel_hi:[1,0,1]
    v_pk_fma_f32 v[154:155], v[154:155], v[156:157], v[156:157] op_sel:[0,0,1] op_sel_hi:[1,0,1]
    v_pk_mul_f32 v[140:141], v[140:141], v[28:29]
    v_pk_mul_f32 v[142:143], v[142:143], v[30:31]
    v_pk_mul_f32 v[144:145], v[144:145], v[32:33]
    v_pk_mul_f32 v[146:147], v[146:147], v[34:35]
    v_pk_mul_f32 v[148:149], v[148:149], v[36:37]
    v_pk_mul_f32 v[150:151], v[150:151], v[38:39]
L_w3_pad22:
    s_cbranch_execz L_w3_pad24
    v_pk_mul_f32 v[152:153], v[152:153], v[40:41]
    v_pk_mul_f32 v[154:155], v[154:155], v[42:43]
    v_exp_f32 v140, v140
    v_exp_f32 v141, v141
    v_exp_f32 v142, v142
    v_exp_f32 v143, v143
    v_exp_f32 v144, v144
    v_exp_f32 v145, v145
    v_exp_f32 v146, v146
    v_exp_f32 v147, v147
    v_exp_f32 v148, v148
    v_exp_f32 v149, v149
    v_exp_f32 v150, v150
    v_exp_f32 v151, v151
    v_exp_f32 v152, v152
    v_exp_f32 v153, v153
    v_exp_f32 v154, v154
    v_exp_f32 v155, v155
    v_mov_b32 v9, 1
    s_cmp_eq_u32 s37, 1
    s_cbranch_scc0 L_p_sigB1_s
    s_waitcnt vmcnt(0)
    s_mov_b64 exec, 1
    buffer_store_dword v9, v2, s[16:19], s35 offen
    s_branch L_p_sigB1_d
L_p_sigB1_s:
    s_waitcnt vmcnt(0)
    s_mov_b64 exec, 1
    buffer_store_dword v9, v2, s[16:19], s35 offen sc0 sc1
L_p_sigB1_d:
    s_mov_b64 exec, -1
    v_pk_mul_f32 v[28:29], v[28:29], v[76:77]
    v_pk_mul_f32 v[30:31], v[30:31], v[78:79]
    v_pk_mul_f32 v[32:33], v[32:33], v[80:81]
    v_pk_mul_f32 v[34:35], v[34:35], v[82:83]
    v_pk_mul_f32 v[36:37], v[36:37], v[84:85]
    v_pk_mul_f32 v[38:39], v[38:39], v[86:87]
    v_pk_mul_f32 v[40:41], v[40:41], v[88:89]
    v_pk_mul_f32 v[42:43], v[42:43], v[90:91]
    v_pk_fma_f32 v[140:141], v[140:141], v[158:159], v[158:159] op_sel_hi:[1,0,0]
    v_pk_fma_f32 v[142:143], v[142:143], v[158:159], v[158:159] op_sel_hi:[1,0,0]
    v_pk_fma_f32 v[144:145], v[144:145], v[158:159], v[158:159] op_sel_hi:[1,0,0]
    v_pk_fma_f32 v[146:147], v[146:147], v[158:159], v[158:159] op_sel_hi:[1,0,0]
    v_pk_fma_f32 v[148:149], v[148:149], v[158:159], v[158:159] op_sel_hi:[1,0,0]
    v_pk_fma_f32 v[150:151], v[150:151], v[158:159], v[158:159] op_sel_hi:[1,0,0]
    v_pk_fma_f32 v[152:153], v[152:153], v[158:159], v[158:159] op_sel_hi:[1,0,0]
    v_pk_fma_f32 v[154:155], v[154:155], v[158:159], v[158:159] op_sel_hi:[1,0,0]
    v_rcp_f32 v140, v140
    v_rcp_f32 v141, v141
    v_rcp_f32 v142, v142
    v_rcp_f32 v143, v143
    v_rcp_f32 v144, v144
    v_rcp_f32 v145, v145
    v_rcp_f32 v146, v146
    v_rcp_f32 v147, v147
    v_rcp_f32 v148, v148
    v_rcp_f32 v149, v149
    v_rcp_f32 v150, v150
    v_rcp_f32 v151, v151
    v_rcp_f32 v152, v152
    v_rcp_f32 v153, v153
    v_rcp_f32 v154, v154
    v_rcp_f32 v155, v155
    s_cmp_eq_u32 s37, 1
    v_pk_mul_f32 v[28:29], v[28:29], v[140:141]
    v_pk_mul_f32 v[30:31], v[30:31], v[142:143]
    v_pk_mul_f32 v[32:33], v[32:33], v[144:145]
    v_pk_mul_f32 v[34:35], v[34:35], v[146:147]
    v_pk_mul_f32 v[36:37], v[36:37], v[148:149]
    v_pk_mul_f32 v[38:39], v[38:39], v[150:151]
    v_pk_mul_f32 v[40:41], v[40:41], v[152:153]
    v_pk_mul_f32 v[42:43], v[42:43], v[154:155]
    v_cvt_pk_bf16_f32 v116, v28, v29
    v_cvt_pk_bf16_f32 v117, v30, v31
    v_cvt_pk_bf16_f32 v118, v32, v33
    v_cvt_pk_bf16_f32 v119, v34, v35
    v_cvt_pk_bf16_f32 v120, v36, v37
    v_cvt_pk_bf16_f32 v121, v38, v39
    v_cvt_pk_bf16_f32 v122, v40, v41
    v_cvt_pk_bf16_f32 v123, v42, v43
    s_cbranch_scc0 L_p_gs1
    buffer_store_dwordx4 v[116:119], v4, s[16:19], s36 offen
    buffer_store_dwordx4 v[120:123], v4, s[16:19], s36 offen offset:1024
    s_branch L_p_gd1
L_p_gs1:
    buffer_store_dwordx4 v[116:119], v4, s[16:19], s36 offen sc1
    buffer_store_dwordx4 v[120:123], v4, s[16:19], s36 offen offset:1024 sc1
L_p_gd1:
    s_add_u32 s36, s36, 2048
L_w3_pad23:
    s_cbranch_execz L_w3_wret
    v_pk_mul_f32 v[140:141], v[44:45], v[44:45]
    v_pk_mul_f32 v[142:143], v[46:47], v[46:47]
    v_pk_mul_f32 v[144:145], v[48:49], v[48:49]
    v_pk_mul_f32 v[146:147], v[50:51], v[50:51]
    v_pk_mul_f32 v[148:149], v[52:53], v[52:53]
    v_pk_mul_f32 v[150:151], v[54:55], v[54:55]
    v_pk_mul_f32 v[152:153], v[56:57], v[56:57]
    v_pk_mul_f32 v[154:155], v[58:59], v[58:59]
    v_pk_fma_f32 v[140:141], v[140:141], v[156:157], v[156:157] op_sel:[0,0,1] op_sel_hi:[1,0,1]
    v_pk_fma_f32 v[142:143], v[142:143], v[156:157], v[156:157] op_sel:[0,0,1] op_sel_hi:[1,0,1]
    v_pk_fma_f32 v[144:145], v[144:145], v[156:157], v[156:157] op_sel:[0,0,1] op_sel_hi:[1,0,1]
    v_pk_fma_f32 v[146:147], v[146:147], v[156:157], v[156:157] op_sel:[0,0,1] op_sel_hi:[1,0,1]
    v_pk_fma_f32 v[148:149], v[148:149], v[156:157], v[156:157] op_sel:[0,0,1] op_sel_hi:[1,0,1]
    v_pk_fma_f32 v[150:151], v[150:151], v[156:157], v[156:157] op_sel:[0,0,1] op_sel_hi:[1,0,1]
    v_pk_fma_f32 v[152:153], v[152:153], v[156:157], v[156:157] op_sel:[0,0,1] op_sel_hi:[1,0,1]
    v_pk_fma_f32 v[154:155], v[154:155], v[156:157], v[156:157] op_sel:[0,0,1] op_sel_hi:[1,0,1]
    v_pk_mul_f32 v[140:141], v[140:141], v[44:45]
    v_pk_mul_f32 v[142:143], v[142:143], v[46:47]
    v_pk_mul_f32 v[144:145], v[144:145], v[48:49]
    v_pk_mul_f32 v[146:147], v[146:147], v[50:51]
    v_pk_mul_f32 v[148:149], v[148:149], v[52:53]
    v_pk_mul_f32 v[150:151], v[150:151], v[54:55]
    v_pk_mul_f32 v[152:153], v[152:153], v[56:57]
    v_pk_mul_f32 v[154:155], v[154:155], v[58:59]
    v_exp_f32 v140, v140
    v_exp_f32 v141, v141
    v_exp_f32 v142, v142
    v_exp_f32 v143, v143
    v_exp_f32 v144, v144
    v_exp_f32 v145, v145
    v_exp_f32 v146, v146
    v_exp_f32 v147, v147
    v_exp_f32 v148, v148
    v_exp_f32 v149, v149
    v_exp_f32 v150, v150
    v_exp_f32 v151, v151
    v_exp_f32 v152, v152
    v_exp_f32 v153, v153
    v_exp_f32 v154, v154
    v_exp_f32 v155, v155
    v_mov_b32 v9, 2
    s_cmp_eq_u32 s37, 1
    s_cbranch_scc0 L_p_sigB2_s
    s_waitcnt vmcnt(0)
    s_mov_b64 exec, 1
    buffer_store_dword v9, v2, s[16:19], s35 offen
    s_branch L_p_sigB2_d
L_p_sigB2_s:
    s_waitcnt vmcnt(0)
    s_mov_b64 exec, 1
    buffer_store_dword v9, v2, s[16:19], s35 offen sc0 sc1
L_p_sigB2_d:
    s_mov_b64 exec, -1
    v_pk_mul_f32 v[44:45], v[44:45], v[92:93]
    v_pk_mul_f32 v[46:47], v[46:47], v[94:95]
    v_pk_mul_f32 v[48:49], v[48:49], v[96:97]
    v_pk_mul_f32 v[50:51], v[50:51], v[98:99]
    v_pk_mul_f32 v[52:53], v[52:53], v[100:101]
    v_pk_mul_f32 v[54:55], v[54:55], v[102:103]
    v_pk_mul_f32 v[56:57], v[56:57], v[104:105]
    v_pk_mul_f32 v[58:59], v[58:59], v[106:107]
    v_pk_fma_f32 v[140:141], v[140:141], v[158:159], v[158:159] op_sel_hi:[1,0,0]
    v_pk_fma_f32 v[142:143], v[142:143], v[158:159], v[158:159] op_sel_hi:[1,0,0]
    v_pk_fma_f32 v[144:145], v[144:145], v[158:159], v[158:159] op_sel_hi:[1,0,0]
    v_pk_fma_f32 v[146:147], v[146:147], v[158:159], v[158:159] op_sel_hi:[1,0,0]
    v_pk_fma_f32 v[148:149], v[148:149], v[158:159], v[158:159] op_sel_hi:[1,0,0]
    v_pk_fma_f32 v[150:151], v[150:151], v[158:159], v[158:159] op_sel_hi:[1,0,0]
    v_pk_fma_f32 v[152:153], v[152:153], v[158:159], v[158:159] op_sel_hi:[1,0,0]
    v_pk_fma_f32 v[154:155], v[154:155], v[158:159], v[158:159] op_sel_hi:[1,0,0]
    v_rcp_f32 v140, v140
    v_rcp_f32 v141, v141
    v_rcp_f32 v142, v142
    v_rcp_f32 v143, v143
    v_rcp_f32 v144, v144
    v_rcp_f32 v145, v145
    v_rcp_f32 v146, v146
    v_rcp_f32 v147, v147
    v_rcp_f32 v148, v148
    v_rcp_f32 v149, v149
    v_rcp_f32 v150, v150
    v_rcp_f32 v151, v151
    v_rcp_f32 v152, v152
    v_rcp_f32 v153, v153
    v_rcp_f32 v154, v154
    v_rcp_f32 v155, v155
    s_cmp_eq_u32 s37, 1
    v_pk_mul_f32 v[44:45], v[44:45], v[140:141]
L_w3_pad24:
    s_cbranch_execz L_w3_wret
    v_pk_mul_f32 v[46:47], v[46:47], v[142:143]
    v_pk_mul_f32 v[48:49], v[48:49], v[144:145]
    v_pk_mul_f32 v[50:51], v[50:51], v[146:147]
    v_pk_mul_f32 v[52:53], v[52:53], v[148:149]
    v_pk_mul_f32 v[54:55], v[54:55], v[150:151]
    v_pk_mul_f32 v[56:57], v[56:57], v[152:153]
    v_pk_mul_f32 v[58:59], v[58:59], v[154:155]
    v_cvt_pk_bf16_f32 v124, v44, v45
    v_cvt_pk_bf16_f32 v125, v46, v47
    v_cvt_pk_bf16_f32 v126, v48, v49
    v_cvt_pk_bf16_f32 v127, v50, v51
    v_cvt_pk_bf16_f32 v128, v52, v53
    v_cvt_pk_bf16_f32 v129, v54, v55
    v_cvt_pk_bf16_f32 v130, v56, v57
    v_cvt_pk_bf16_f32 v131, v58, v59
    s_cbranch_scc0 L_p_gs2
    buffer_store_dwordx4 v[124:127], v4, s[16:19], s36 offen
    buffer_store_dwordx4 v[128:131], v4, s[16:19], s36 offen offset:1024
    s_branch L_p_gd2
L_p_gs2:
    buffer_store_dwordx4 v[124:127], v4, s[16:19], s36 offen sc1
    buffer_store_dwordx4 v[128:131], v4, s[16:19], s36 offen offset:1024 sc1
L_p_gd2:
    v_mov_b32 v9, 3
L_p_toC:
    s_mov_b32 s41, 1
    v_and_b32 v10, 31, v1
    v_lshrrev_b32 v3, 5, v1
    s_lshr_b32 s31, s24, 1
    s_lshl_b32 s31, s31, 2
    v_add_u32 v3, s31, v3
    v_xor_b32 v3, v3, v10
    v_and_b32 v3, 7, v3
    v_lshlrev_b32 v10, 7, v10
    v_lshl_add_u32 v10, v3, 4, v10
    s_lshl_b32 s31, s45, 12
    s_add_u32 s31, s31, 57344
    v_add_u32 v10, s31, v10
    v_xor_b32 v158, 32, v10
    v_lshrrev_b32 v156, 3, v1
    v_xor_b32 v157, v156, v1
    v_and_b32 v157, 7, v157
    v_lshlrev_b32 v156, 10, v156
    v_lshl_add_u32 v156, v157, 4, v156
    s_lshl_b32 s31, s24, 11
    s_add_u32 s31, s31, 57344
    v_add_u32 v157, s31, v4
    s_lshl_b32 s42, s27, 16
    s_lshl_b32 s31, s24, 14
    s_add_u32 s42, s42, s31
    s_lshl_b32 s31, s28, 7
    s_add_u32 s42, s42, s31
    s_add_u32 s43, s42, 8192
    s_mov_b32 s34, 10
    s_branch L_p_gemm
L_p_b14:
    v_mov_b32 v9, 3
    s_cmp_eq_u32 s37, 1
    s_cbranch_scc0 L_p_sigB14_s
    s_waitcnt vmcnt(0)
    s_mov_b64 exec, 1
    buffer_store_dword v9, v2, s[16:19], s35 offen
    s_branch L_p_sigB14_d
L_p_sigB14_s:
    s_waitcnt vmcnt(0)
    s_mov_b64 exec, 1
    buffer_store_dword v9, v2, s[16:19], s35 offen sc0 sc1
L_p_sigB14_d:
    s_mov_b64 exec, -1
    s_branch L_p_toC
L_p_final:
    ds_write_b128 v10, v[160:163]
    ds_write_b128 v158, v[164:167]
    s_waitcnt lgkmcnt(0)
    s_barrier
    ds_read_b128 v[108:111], v157
    ds_read_b128 v[112:115], v157 offset:1024
    s_waitcnt lgkmcnt(1)
    buffer_store_dwordx4 v[108:111], v156, s[20:23], s42 offen sc1
    s_waitcnt lgkmcnt(0)
    buffer_store_dwordx4 v[112:115], v156, s[20:23], s43 offen sc1
    s_endpgm
.section .rodata,"a"
.p2align 6
.amdhsa_kernel qkv_kernel
  .amdhsa_next_free_vgpr 152
  .amdhsa_next_free_sgpr 80
  .amdhsa_accum_offset 152
  .amdhsa_group_segment_fixed_size 0
  .amdhsa_kernarg_size 80
  .amdhsa_user_sgpr_count 2
  .amdhsa_user_sgpr_kernarg_segment_ptr 1
  .amdhsa_system_sgpr_workgroup_id_x 1
.end_amdhsa_kernel
.p2align 6
.amdhsa_kernel main_kernel
  .amdhsa_next_free_vgpr 168
  .amdhsa_next_free_sgpr 80
  .amdhsa_accum_offset 168
  .amdhsa_group_segment_fixed_size 0
  .amdhsa_kernarg_size 80
  .amdhsa_user_sgpr_count 2
  .amdhsa_user_sgpr_kernarg_segment_ptr 1
  .amdhsa_system_sgpr_workgroup_id_x 1
.end_amdhsa_kernel
```
